```python
import torch

def _softmax(x, axis=-1):
    return torch.softmax(x, dim=axis)

def _gelu(x):
    return torch.nn.functional.gelu(x, approximate='tanh')

def _silu(x):
    return torch.nn.functional.silu(x)

def _sigmoid(x):
    return torch.sigmoid(x)

def _layernorm(x, axis=-1, eps=1e-05):
    m = x.mean(dim=axis, keepdim=True)
    v = x.var(dim=axis, keepdim=True, unbiased=False)
    return (x - m) / torch.sqrt(v + eps)

def _scatter_add(tgt, idx, src, axis=0):
    return tgt.clone().index_add_(axis, idx, src)

def _segment_sum(src, seg, n):
    out = torch.zeros((n,) + src.shape[1:], dtype=src.dtype)
    return out.index_add_(0, seg, src)

def _pad(x, pw):
    flat = tuple((v for pair in reversed(pw) for v in pair))
    return torch.nn.functional.pad(x, flat)
kernel_name = 'adaLN_cond__gqa_block_cached__swiglu_ffn__decode'

def setup_inputs():

    _w = lambda a: (lambda t: t.to(torch.bfloat16) if t.is_floating_point() else t)(torch.as_tensor(a))

    def _A_setup():
        B, Sq, D = (2, 1, 448)
        Hq, Hkv, Sk, Dh = (16, 8, 8192, 256)
        assert Hq % Hkv == 0, (Hq, Hkv)
        return {'x': _w((lambda *s: torch.randn(*s, dtype=torch.bfloat16) * 0.05)(B, Sq, D)), 'k_cache': _w((lambda *s: torch.randn(*s, dtype=torch.bfloat16) * 3.2)(B, Hkv, Sk, Dh)), 'v_cache': _w((lambda *s: torch.randn(*s, dtype=torch.bfloat16) * 0.4)(B, Hkv, Sk, Dh)), 'wq': _w((lambda *s: torch.randn(*s, dtype=torch.bfloat16) * 3.2)(D, Hq * Dh) * D ** (-0.5)), 'wo': _w((lambda *s: torch.randn(*s, dtype=torch.bfloat16) * 0.4)(Hq * Dh, D) * (Hq * Dh) ** (-0.5))}
    _A_in = _A_setup()

    def _B_setup():
        B, S, D, F = (2, 1, 448, 1792)
        return {'x': _w((lambda *s: torch.randn(*s, dtype=torch.bfloat16) * 0.05)(B, S, D)), 'w_gate': _w((lambda *s: torch.randn(*s, dtype=torch.bfloat16) * 0.05)(D, F)), 'w_up': _w((lambda *s: torch.randn(*s, dtype=torch.bfloat16) * 0.05)(D, F)), 'w_down': _w((lambda *s: torch.randn(*s, dtype=torch.bfloat16) * 0.05)(F, D))}
    _B_in = _B_setup()
    return {'A_x': _A_in['x'], 'A_k_cache': _A_in['k_cache'], 'A_v_cache': _A_in['v_cache'], 'A_wq': _A_in['wq'], 'A_wo': _A_in['wo'], 'B_x': _B_in['x'], 'B_w_gate': _B_in['w_gate'], 'B_w_up': _B_in['w_up'], 'B_w_down': _B_in['w_down'], 'c': _w((lambda *s: torch.randn(*s, dtype=torch.bfloat16) * 0.2)(2, 448) * 8.0), 'w_mod': _w((lambda *s: torch.randn(*s, dtype=torch.bfloat16) * 0.2)(448, 6 * 448) * 448 ** (-0.5) * 8.0)}

def reference(A_x, A_k_cache, A_v_cache, A_wq, A_wo, B_x, B_w_gate, B_w_up, B_w_down, c, w_mod):

    def _A_ref(x, k_cache, v_cache, wq, wo):
        B, Sq, D = x.shape
        Hq, Dh = (16, 256)
        Hkv = k_cache.shape[1]
        rep = Hq // Hkv
        q = (lambda x, *d: x.permute(*d))((x @ wq).reshape(B, Sq, Hq, Dh), 0, 2, 1, 3)
        k = (lambda x, n, axis: torch.repeat_interleave(x, n, dim=axis))(k_cache, rep, axis=1)
        v = (lambda x, n, axis: torch.repeat_interleave(x, n, dim=axis))(v_cache, rep, axis=1)
        scores = torch.einsum('bhqd,bhkd->bhqk', q, k) * Dh ** (-0.5)
        p = _softmax(scores, axis=-1)
        o = torch.einsum('bhqk,bhkd->bhqd', p, v)
        return (lambda x, *d: x.permute(*d))(o, 0, 2, 1, 3).reshape(B, Sq, Hq * Dh) @ wo

    def _B_ref(x, w_gate, w_up, w_down):
        g = _silu(x @ w_gate)
        u = x @ w_up
        return g * u @ w_down
    x = A_x
    mod = (_silu(c) @ w_mod).reshape(c.shape[0], 6, 1, -1)
    sa, ca, ga, sb, cb, gb = (mod[:, 0].clone(), mod[:, 1].clone(), mod[:, 2].clone(), mod[:, 3].clone(), mod[:, 4].clone(), mod[:, 5].clone())
    h = _layernorm(x, axis=-1) * (1 + ca) + sa
    x = x + ga * _A_ref(h, A_k_cache, A_v_cache, A_wq, A_wo)
    h = _layernorm(x, axis=-1) * (1 + cb) + sb
    x = x + gb * _B_ref(h, B_w_gate, B_w_up, B_w_down)
    return x
```

```asm
; @launch grid=(256,1,1) block=(768,1,1) lds=163840
.amdgcn_target "amdgcn-amd-amdhsa--gfx950"
.text
.globl adaLN_cond__gqa_block_cached__swiglu_ffn__decode_kernel
.p2align 8
.type adaLN_cond__gqa_block_cached__swiglu_ffn__decode_kernel,@function
adaLN_cond__gqa_block_cached__swiglu_ffn__decode_kernel:
    s_cmp_ge_u32 s2, 256
    s_cbranch_scc1 L_end
    s_load_dwordx16 s[16:31], s[0:1], 0
    s_load_dwordx8 s[32:39], s[0:1], 64
    s_load_dwordx4 s[40:43], s[0:1], 96
    v_lshrrev_b32 v2, 6, v0
    v_and_b32 v1, 63, v0
    v_readfirstlane_b32 s3, v2
    s_and_b32 s4, s2, 7
    s_lshr_b32 s5, s2, 3
    s_lshr_b32 s6, s5, 4
    s_and_b32 s7, s5, 15
    s_lshr_b32 s8, s5, 2
    s_lshr_b32 s10, s5, 1
    s_lshl_b32 s10, s10, 2
    s_lshr_b32 s12, s4, 1
    s_add_u32 s10, s10, s12
    s_and_b32 s9, s4, 1
    s_lshl_b32 s9, s9, 1
    s_and_b32 s12, s5, 1
    s_add_u32 s9, s9, s12
    s_add_u32 s12, s4, 56
    s_sub_u32 s13, s5, 14
    s_cmp_ge_u32 s5, 14
    s_cselect_b32 s10, s12, s10
    s_cselect_b32 s9, s13, s9
    s_cmp_ge_u32 s5, 18
    s_cselect_b32 s10, 40, s10
    s_mov_b32 s54, 268435456
    s_mov_b32 s55, 0x20000
    s_cmp_lg_u32 s3, 0
    s_cbranch_scc1 L_notld
    s_mov_b32 s46, 0x4000000
    s_mov_b32 s47, 0x20000
    s_lshl_b32 s12, s6, 3
    s_add_u32 s12, s12, s4
    s_lshl_b32 s12, s12, 4
    s_add_u32 s12, s12, s7
    s_lshl_b32 s56, s12, 18
    v_lshrrev_b32 v6, 5, v1
    v_and_b32 v7, 31, v1
    v_lshlrev_b32 v8, 1, v6
    v_xor_b32 v7, v7, v8
    v_lshlrev_b32 v7, 4, v7
    v_lshl_add_u32 v8, v6, 9, v7
    v_xor_b32 v9, 64, v8
    v_xor_b32 v10, 128, v8
    v_xor_b32 v11, 192, v8
    s_mov_b32 s12, s56
    s_mov_b32 s57, 0
    s_mov_b32 s14, 0
    s_mov_b32 m0, 0
    v_mov_b32 v4, 163464
    v_mov_b32 v3, 163472
    v_mov_b32 v6, 163472
    v_mov_b32 v12, 163512
    s_waitcnt lgkmcnt(0)
    s_mov_b32 s44, s18
    s_mov_b32 s45, s19
    s_mov_b32 s52, s42
    s_mov_b32 s53, s43
L_ldw4:
    s_sub_i32 s58, s57, 3
    s_max_i32 s58, s58, 0
    s_waitcnt vmcnt(31)
    buffer_load_dwordx4 v8, s[44:47], s12 offen offset:0 nt lds
    s_waitcnt vmcnt(31)
    buffer_load_dwordx4 v9, s[44:47], s12 offen offset:1024 nt lds
    s_waitcnt vmcnt(31)
    buffer_load_dwordx4 v10, s[44:47], s12 offen offset:2048 nt lds
    s_waitcnt vmcnt(31)
    buffer_load_dwordx4 v11, s[44:47], s12 offen offset:3072 nt lds
    s_waitcnt vmcnt(31)
    s_add_u32 m0, s14, 4096
    s_add_u32 s12, s12, 4096
    buffer_load_dwordx4 v8, s[44:47], s12 offen offset:0 nt lds
    s_waitcnt vmcnt(31)
    buffer_load_dwordx4 v9, s[44:47], s12 offen offset:1024 nt lds
    s_waitcnt vmcnt(31)
    buffer_load_dwordx4 v10, s[44:47], s12 offen offset:2048 nt lds
    v_mov_b32 v5, s58
    s_mov_b64 exec, 1
    s_waitcnt vmcnt(31)
    ds_max_u32 v4, v5
    s_mov_b64 exec, -1
    ds_read_b32 v7, v6
    ds_read_b32 v13, v12
    buffer_load_dwordx4 v11, s[44:47], s12 offen offset:3072 nt lds
    s_add_u32 s12, s12, 4096
    s_add_u32 s57, s57, 1
    s_cmp_ge_u32 s57, 5
    s_cbranch_scc1 L_ld
    s_add_u32 s14, s14, 16384
    s_mov_b32 m0, s14
L_ldw3:
    s_sub_i32 s58, s57, 3
    s_max_i32 s58, s58, 0
    s_waitcnt vmcnt(27)
    buffer_load_dwordx4 v8, s[44:47], s12 offen offset:0 nt lds
    s_waitcnt vmcnt(27)
    buffer_load_dwordx4 v9, s[44:47], s12 offen offset:1024 nt lds
    s_waitcnt vmcnt(27)
    buffer_load_dwordx4 v10, s[44:47], s12 offen offset:2048 nt lds
    v_mov_b32 v5, s58
    s_mov_b64 exec, 1
    s_waitcnt vmcnt(27)
    ds_max_u32 v4, v5
    s_mov_b64 exec, -1
    buffer_load_dwordx4 v11, s[44:47], s12 offen offset:3072 nt lds
    s_waitcnt vmcnt(27)
    s_add_u32 m0, s14, 4096
    s_add_u32 s12, s12, 4096
    buffer_load_dwordx4 v8, s[44:47], s12 offen offset:0 nt lds
    s_waitcnt vmcnt(27)
    buffer_load_dwordx4 v9, s[44:47], s12 offen offset:1024 nt lds
    s_waitcnt vmcnt(27)
    buffer_load_dwordx4 v10, s[44:47], s12 offen offset:2048 nt lds
    s_waitcnt vmcnt(27)
    ds_read_b32 v7, v6
    ds_read_b32 v13, v12
    buffer_load_dwordx4 v11, s[44:47], s12 offen offset:3072 nt lds
    s_add_u32 s12, s12, 4096
    s_add_u32 s57, s57, 1
    s_cmp_ge_u32 s57, 5
    s_cbranch_scc1 L_ld
    s_add_u32 s14, s14, 16384
    s_mov_b32 m0, s14
    s_mov_b32 s61, 1
    s_cmp_lt_u32 s10, 28
    s_cselect_b32 s61, 2, s61
    s_cmp_lt_u32 s10, 14
    s_cselect_b32 s61, 3, s61
    s_barrier
L_ldw2:
    s_sub_i32 s58, s57, 2
    s_max_i32 s58, s58, 0
    s_waitcnt vmcnt(23)
    buffer_load_dwordx4 v8, s[44:47], s12 offen offset:0 nt lds
    s_waitcnt vmcnt(23)
    buffer_load_dwordx4 v9, s[44:47], s12 offen offset:1024 nt lds
    s_waitcnt vmcnt(23)
    buffer_load_dwordx4 v10, s[44:47], s12 offen offset:2048 nt lds
    s_waitcnt vmcnt(23)
    buffer_load_dwordx4 v11, s[44:47], s12 offen offset:3072 nt lds
    s_waitcnt vmcnt(23)
    s_add_u32 m0, s14, 4096
    s_add_u32 s12, s12, 4096
    buffer_load_dwordx4 v8, s[44:47], s12 offen offset:0 nt lds
    s_waitcnt vmcnt(23)
    buffer_load_dwordx4 v9, s[44:47], s12 offen offset:1024 nt lds
    s_waitcnt vmcnt(23)
    buffer_load_dwordx4 v10, s[44:47], s12 offen offset:2048 nt lds
    v_mov_b32 v5, s58
    s_mov_b64 exec, 1
    s_waitcnt vmcnt(23)
    ds_max_u32 v4, v5
    s_mov_b64 exec, -1
    ds_read_b32 v7, v6
    ds_read_b32 v13, v12
    buffer_load_dwordx4 v11, s[44:47], s12 offen offset:3072 nt lds
    s_add_u32 s12, s12, 4096
    s_add_u32 s57, s57, 1
    s_cmp_ge_u32 s57, 5
    s_cbranch_scc1 L_ld
    s_add_u32 s14, s14, 16384
    s_mov_b32 m0, s14
L_ldw1:
    s_sub_i32 s58, s57, 2
    s_max_i32 s58, s58, 0
    s_waitcnt vmcnt(20)
    buffer_load_dwordx4 v8, s[44:47], s12 offen offset:0 nt lds
    s_waitcnt vmcnt(20)
    buffer_load_dwordx4 v9, s[44:47], s12 offen offset:1024 nt lds
    s_waitcnt vmcnt(20)
    buffer_load_dwordx4 v10, s[44:47], s12 offen offset:2048 nt lds
    s_waitcnt vmcnt(20)
    buffer_load_dwordx4 v11, s[44:47], s12 offen offset:3072 nt lds
    v_mov_b32 v5, s58
    s_mov_b64 exec, 1
    s_waitcnt vmcnt(20)
    ds_max_u32 v4, v5
    s_mov_b64 exec, -1
    s_add_u32 m0, s14, 4096
    s_add_u32 s12, s12, 4096
    buffer_load_dwordx4 v8, s[44:47], s12 offen offset:0 nt lds
    s_waitcnt vmcnt(20)
    buffer_load_dwordx4 v9, s[44:47], s12 offen offset:1024 nt lds
    s_waitcnt vmcnt(20)
    buffer_load_dwordx4 v10, s[44:47], s12 offen offset:2048 nt lds
    s_waitcnt vmcnt(20)
    ds_read_b32 v7, v6
    ds_read_b32 v13, v12
    buffer_load_dwordx4 v11, s[44:47], s12 offen offset:3072 nt lds
    s_add_u32 s12, s12, 4096
    s_add_u32 s57, s57, 1
    s_cmp_ge_u32 s57, 5
    s_cbranch_scc1 L_ld
    s_add_u32 s14, s14, 16384
    s_mov_b32 m0, s14
L_ldw0:
    s_sub_i32 s58, s57, 2
    s_max_i32 s58, s58, 0
    s_waitcnt vmcnt(18)
    buffer_load_dwordx4 v8, s[44:47], s12 offen offset:0 nt lds
    s_waitcnt vmcnt(18)
    buffer_load_dwordx4 v9, s[44:47], s12 offen offset:1024 nt lds
    v_mov_b32 v5, s58
    s_mov_b64 exec, 1
    s_waitcnt vmcnt(18)
    ds_max_u32 v4, v5
    s_mov_b64 exec, -1
    buffer_load_dwordx4 v10, s[44:47], s12 offen offset:2048 nt lds
    s_waitcnt vmcnt(18)
    buffer_load_dwordx4 v11, s[44:47], s12 offen offset:3072 nt lds
    s_waitcnt vmcnt(18)
    s_add_u32 m0, s14, 4096
    s_add_u32 s12, s12, 4096
    buffer_load_dwordx4 v8, s[44:47], s12 offen offset:0 nt lds
    s_waitcnt vmcnt(18)
    buffer_load_dwordx4 v9, s[44:47], s12 offen offset:1024 nt lds
    s_waitcnt vmcnt(18)
    buffer_load_dwordx4 v10, s[44:47], s12 offen offset:2048 nt lds
    s_waitcnt vmcnt(18)
    ds_read_b32 v7, v6
    ds_read_b32 v13, v12
    buffer_load_dwordx4 v11, s[44:47], s12 offen offset:3072 nt lds
    s_add_u32 s12, s12, 4096
    s_add_u32 s57, s57, 1
L_ld:
    s_cmp_ge_u32 s57, 64
    s_cbranch_scc1 L_ldend
    s_cmp_lg_u32 s57, 32
    s_cbranch_scc1 L_ld1
    s_mov_b32 s44, s20
    s_mov_b32 s45, s21
    s_mov_b32 s12, s56
L_ld1:
    s_waitcnt lgkmcnt(0)
    v_readfirstlane_b32 s62, v13
    v_readfirstlane_b32 s13, v7
    s_and_b32 s63, s57, 7
    s_lshl_b32 s14, s63, 14
    s_and_b32 s59, s57, 8
    s_lshl_b32 s59, s59, 10
    s_add_u32 s14, s14, s59
    s_cmp_lg_u32 s62, 0
    s_cselect_b32 s61, s62, s61
    s_lshr_b32 s59, s57, 3
    s_add_u32 s13, s13, 1
    s_cmp_lt_u32 s13, s59
    s_cbranch_scc1 L_ld4
L_ld2:
    s_add_u32 s63, s63, 1
    s_and_b32 s63, s63, 7
    s_lshl_b32 s63, s63, 2
    v_add_u32 v6, s63, v3
    s_mov_b32 m0, s14
    s_cmp_eq_u32 s61, 1
    s_cbranch_scc1 L_ldw0
    s_cmp_eq_u32 s61, 2
    s_cbranch_scc1 L_ldw1
    s_cmp_eq_u32 s61, 3
    s_cbranch_scc1 L_ldw2
    s_cmp_eq_u32 s61, 4
    s_cbranch_scc1 L_ldw3
    s_branch L_ldw4
L_ld4:
    s_mov_b32 s15, 262136
L_ld3:
    ds_read_b32 v7, v6
    s_waitcnt lgkmcnt(0)
    v_readfirstlane_b32 s13, v7
    s_nop 0
    s_add_u32 s13, s13, 1
    s_cmp_ge_u32 s13, s59
    s_nop 0
    s_cbranch_scc1 L_ld2
    s_waitcnt vmcnt(0)
    v_mov_b32 v5, s57
    s_mov_b64 exec, 1
    ds_max_u32 v4, v5
    s_mov_b64 exec, -1
    s_sleep 1
    s_sub_u32 s15, s15, 1
    s_cmp_lg_u32 s15, 0
    s_cbranch_scc1 L_ld3
    s_branch L_ld2
L_ldend:
    s_cmp_lg_u32 s10, 40
    s_cbranch_scc1 L_ldnw
    v_lshrrev_b32 v14, 1, v1
    v_lshlrev_b32 v14, 12, v14
    v_and_b32 v15, 1, v1
    v_lshl_add_u32 v14, v15, 7, v14
    s_lshr_b32 s13, s56, 22
    s_lshl_b32 s13, s13, 16
    s_lshl_b32 s14, s7, 8
    s_add_u32 s13, s13, s14
    s_add_u32 s13, s13, 1048576
    s_mov_b32 exec_hi, 0
    s_mov_b32 m0, 163648
    s_nop 0
    buffer_load_dword v14, s[52:55], s13 offen lds
    s_mov_b64 exec, -1
    s_mov_b32 s61, s4
    s_sub_u32 s62, s5, 18
    s_lshl_b32 s12, s61, 2
    s_add_u32 s63, s12, s3
    s_mul_i32 s60, s3, 6144
    s_add_u32 s60, s60, 131072
    s_mov_b32 s48, s24
    s_mov_b32 s49, s25
    s_mov_b32 s50, 3670016
    s_mov_b32 s51, 0x20000
    s_mul_i32 s46, s63, 114688
    s_lshl_b32 s13, s62, 6
    s_add_u32 s46, s46, s13
    v_lshrrev_b32 v14, 2, v1
    v_mul_u32_u24 v14, 896, v14
    v_lshrrev_b32 v15, 3, v1
    v_and_b32 v15, 2, v15
    v_xor_b32 v15, v15, v1
    v_and_b32 v15, 3, v15
    v_lshl_add_u32 v14, v15, 4, v14
    s_add_u32 s13, s46, 28672
    s_add_u32 m0, s60, 0
    s_nop 0
    buffer_load_dwordx4 v14, s[48:51], s13 offen nt lds
    s_add_u32 s13, s46, 43008
    s_add_u32 m0, s60, 1024
    s_nop 0
    buffer_load_dwordx4 v14, s[48:51], s13 offen nt lds
    s_add_u32 s13, s46, 57344
    s_add_u32 m0, s60, 2048
    s_nop 0
    buffer_load_dwordx4 v14, s[48:51], s13 offen nt lds
    s_add_u32 s13, s46, 71680
    s_add_u32 m0, s60, 3072
    s_nop 0
    buffer_load_dwordx4 v14, s[48:51], s13 offen nt lds
    s_add_u32 s13, s46, 86016
    s_add_u32 m0, s60, 4096
    s_nop 0
    buffer_load_dwordx4 v14, s[48:51], s13 offen nt lds
    s_add_u32 s13, s46, 100352
    s_add_u32 m0, s60, 5120
    s_nop 0
    buffer_load_dwordx4 v14, s[48:51], s13 offen nt lds
    s_mov_b64 exec, 1
    v_mov_b32 v5, 61
    s_waitcnt vmcnt(31)
    ds_max_u32 v4, v5
    v_mov_b32 v5, 62
    s_waitcnt vmcnt(23)
    ds_max_u32 v4, v5
    v_mov_b32 v5, 63
    s_waitcnt vmcnt(15)
    ds_max_u32 v4, v5
    v_mov_b32 v5, 64
    s_waitcnt vmcnt(7)
    ds_max_u32 v4, v5
    s_mov_b64 exec, -1
    s_branch L_ldw
L_ldnw:
    v_lshrrev_b32 v14, 1, v1
    v_lshlrev_b32 v14, 12, v14
    v_and_b32 v15, 1, v1
    v_lshl_add_u32 v14, v15, 7, v14
    s_lshr_b32 s13, s56, 22
    s_lshl_b32 s13, s13, 16
    s_lshl_b32 s14, s7, 8
    s_add_u32 s13, s13, s14
    s_add_u32 s13, s13, 1048576
    s_mov_b32 exec_hi, 0
    s_mov_b32 m0, 163648
    s_nop 0
    buffer_load_dword v14, s[52:55], s13 offen lds
    s_mov_b64 exec, -1
    s_mov_b64 exec, 1
    v_mov_b32 v5, 61
    s_waitcnt vmcnt(25)
    ds_max_u32 v4, v5
    v_mov_b32 v5, 62
    s_waitcnt vmcnt(17)
    ds_max_u32 v4, v5
    v_mov_b32 v5, 63
    s_waitcnt vmcnt(9)
    ds_max_u32 v4, v5
    v_mov_b32 v5, 64
    s_waitcnt vmcnt(1)
    ds_max_u32 v4, v5
    s_mov_b64 exec, -1
L_ldw:
    v_mov_b32 v6, 163460
    ds_read_b32 v7, v6
    s_waitcnt lgkmcnt(0)
    v_readfirstlane_b32 s11, v7
    s_nop 3
    s_branch L_hbar2b
L_notld:
    v_mov_b32 v2, 0
    s_waitcnt lgkmcnt(0)
    s_mov_b32 s52, s42
    s_mov_b32 s53, s43
    s_cmp_ge_u32 s3, 4
    s_cbranch_scc1 L_att
L_help:
    s_cmp_eq_u32 s3, 1
    s_cbranch_scc1 L_h1
    s_cmp_lg_u32 s3, 2
    s_cbranch_scc1 L_hidle
    s_cmp_ge_u32 s10, 28
    s_cbranch_scc1 L_hidle
    s_mov_b32 s64, s34
    s_mov_b32 s65, s35
    s_mov_b32 s66, 1792
    s_mov_b32 s67, 0x20000
    s_mov_b32 s56, s36
    s_mov_b32 s57, s37
    s_mov_b32 s58, 2408448
    s_mov_b32 s59, 0x20000
    v_lshlrev_b32 v3, 2, v1
    buffer_load_dword v128, v3, s[64:67], 0 offen offset:0
    buffer_load_dword v129, v3, s[64:67], 0 offen offset:256
    buffer_load_dword v130, v3, s[64:67], 0 offen offset:512
    buffer_load_dword v131, v3, s[64:67], 0 offen offset:768
    buffer_load_dword v132, v3, s[64:67], 0 offen offset:1024
    buffer_load_dword v133, v3, s[64:67], 0 offen offset:1280
    buffer_load_dword v134, v3, s[64:67], 0 offen offset:1536
    buffer_load_dword v135, v2, s[52:55], 0 offen sc1
    s_mov_b32 s60, 131072
    s_cmp_ge_u32 s10, 14
    s_cbranch_scc1 L_h0late
    v_lshrrev_b32 v4, 1, v1
    v_mul_u32_u24 v4, 5376, v4
    v_and_b32 v5, 1, v1
    v_lshl_add_u32 v4, v5, 4, v4
    s_lshl_b32 s12, s4, 2
    s_and_b32 s13, s5, 3
    s_add_u32 s12, s12, s13
    s_and_b32 s14, s5, 4
    s_lshl_b32 s14, s14, 3
    s_add_u32 s12, s12, s14
    s_lshl_b32 s14, s4, 1
    s_add_u32 s14, s14, s13
    s_add_u32 s14, s14, 40
    s_cmp_ge_u32 s12, 48
    s_cselect_b32 s12, s14, s12
    s_lshl_b32 s14, s12, 5
    s_add_u32 s13, s14, 0
    s_add_u32 m0, s60, 0
    s_nop 0
    buffer_load_dwordx4 v4, s[56:59], s13 offen nt lds
    s_add_u32 s13, s14, 172032
    s_add_u32 m0, s60, 1024
    s_nop 0
    buffer_load_dwordx4 v4, s[56:59], s13 offen nt lds
    s_add_u32 s13, s14, 344064
    s_add_u32 m0, s60, 2048
    s_nop 0
    buffer_load_dwordx4 v4, s[56:59], s13 offen nt lds
    s_add_u32 s13, s14, 516096
    s_add_u32 m0, s60, 3072
    s_nop 0
    buffer_load_dwordx4 v4, s[56:59], s13 offen nt lds
    s_add_u32 s13, s14, 688128
    s_add_u32 m0, s60, 4096
    s_nop 0
    buffer_load_dwordx4 v4, s[56:59], s13 offen nt lds
    s_add_u32 s13, s14, 860160
    s_add_u32 m0, s60, 5120
    s_nop 0
    buffer_load_dwordx4 v4, s[56:59], s13 offen nt lds
    s_add_u32 s13, s14, 1032192
    s_add_u32 m0, s60, 6144
    s_nop 0
    buffer_load_dwordx4 v4, s[56:59], s13 offen nt lds
    s_add_u32 s13, s14, 1204224
    s_add_u32 m0, s60, 7168
    s_nop 0
    buffer_load_dwordx4 v4, s[56:59], s13 offen nt lds
    s_add_u32 s13, s14, 1376256
    s_add_u32 m0, s60, 8192
    s_nop 0
    buffer_load_dwordx4 v4, s[56:59], s13 offen nt lds
    s_add_u32 s13, s14, 1548288
    s_add_u32 m0, s60, 9216
    s_nop 0
    buffer_load_dwordx4 v4, s[56:59], s13 offen nt lds
    s_add_u32 s13, s14, 1720320
    s_add_u32 m0, s60, 10240
    s_nop 0
    buffer_load_dwordx4 v4, s[56:59], s13 offen nt lds
    s_add_u32 s13, s14, 1892352
    s_add_u32 m0, s60, 11264
    s_nop 0
    buffer_load_dwordx4 v4, s[56:59], s13 offen nt lds
    s_add_u32 s13, s14, 2064384
    s_add_u32 m0, s60, 12288
    s_nop 0
    buffer_load_dwordx4 v4, s[56:59], s13 offen nt lds
    s_add_u32 s13, s14, 2236416
    s_add_u32 m0, s60, 13312
    s_nop 0
    buffer_load_dwordx4 v4, s[56:59], s13 offen nt lds
    s_barrier
    s_waitcnt vmcnt(14)
    v_readfirstlane_b32 s11, v135
    s_nop 0
    s_mul_i32 s11, s11, 1664525
    s_add_u32 s11, s11, 1013904223
    v_add_u32 v3, 159744, v3
    v_lshlrev_b32 v6, 16, v128
    v_and_b32 v7, 0xffff0000, v128
    v_mul_f32 v8, 0xbfb8aa3b, v6
    v_exp_f32 v8, v8
    s_nop 0
    v_add_f32 v8, 1.0, v8
    v_rcp_f32 v8, v8
    s_nop 0
    v_mul_f32 v6, v6, v8
    v_mul_f32 v9, 0xbfb8aa3b, v7
    v_exp_f32 v9, v9
    s_nop 0
    v_add_f32 v9, 1.0, v9
    v_rcp_f32 v9, v9
    s_nop 0
    v_mul_f32 v7, v7, v9
    v_cvt_pk_bf16_f32 v6, v6, v7
    ds_write_b32 v3, v6 offset:0
    v_lshlrev_b32 v6, 16, v129
    v_and_b32 v7, 0xffff0000, v129
    v_mul_f32 v8, 0xbfb8aa3b, v6
    v_exp_f32 v8, v8
    s_nop 0
    v_add_f32 v8, 1.0, v8
    v_rcp_f32 v8, v8
    s_nop 0
    v_mul_f32 v6, v6, v8
    v_mul_f32 v9, 0xbfb8aa3b, v7
    v_exp_f32 v9, v9
    s_nop 0
    v_add_f32 v9, 1.0, v9
    v_rcp_f32 v9, v9
    s_nop 0
    v_mul_f32 v7, v7, v9
    v_cvt_pk_bf16_f32 v6, v6, v7
    ds_write_b32 v3, v6 offset:256
    v_lshlrev_b32 v6, 16, v130
    v_and_b32 v7, 0xffff0000, v130
    v_mul_f32 v8, 0xbfb8aa3b, v6
    v_exp_f32 v8, v8
    s_nop 0
    v_add_f32 v8, 1.0, v8
    v_rcp_f32 v8, v8
    s_nop 0
    v_mul_f32 v6, v6, v8
    v_mul_f32 v9, 0xbfb8aa3b, v7
    v_exp_f32 v9, v9
    s_nop 0
    v_add_f32 v9, 1.0, v9
    v_rcp_f32 v9, v9
    s_nop 0
    v_mul_f32 v7, v7, v9
    v_cvt_pk_bf16_f32 v6, v6, v7
    ds_write_b32 v3, v6 offset:512
    v_lshlrev_b32 v6, 16, v131
    v_and_b32 v7, 0xffff0000, v131
    v_mul_f32 v8, 0xbfb8aa3b, v6
    v_exp_f32 v8, v8
    s_nop 0
    v_add_f32 v8, 1.0, v8
    v_rcp_f32 v8, v8
    s_nop 0
    v_mul_f32 v6, v6, v8
    v_mul_f32 v9, 0xbfb8aa3b, v7
    v_exp_f32 v9, v9
    s_nop 0
    v_add_f32 v9, 1.0, v9
    v_rcp_f32 v9, v9
    s_nop 0
    v_mul_f32 v7, v7, v9
    v_cvt_pk_bf16_f32 v6, v6, v7
    ds_write_b32 v3, v6 offset:768
    v_lshlrev_b32 v6, 16, v132
    v_and_b32 v7, 0xffff0000, v132
    v_mul_f32 v8, 0xbfb8aa3b, v6
    v_exp_f32 v8, v8
    s_nop 0
    v_add_f32 v8, 1.0, v8
    v_rcp_f32 v8, v8
    s_nop 0
    v_mul_f32 v6, v6, v8
    v_mul_f32 v9, 0xbfb8aa3b, v7
    v_exp_f32 v9, v9
    s_nop 0
    v_add_f32 v9, 1.0, v9
    v_rcp_f32 v9, v9
    s_nop 0
    v_mul_f32 v7, v7, v9
    v_cvt_pk_bf16_f32 v6, v6, v7
    ds_write_b32 v3, v6 offset:1024
    v_lshlrev_b32 v6, 16, v133
    v_and_b32 v7, 0xffff0000, v133
    v_mul_f32 v8, 0xbfb8aa3b, v6
    v_exp_f32 v8, v8
    s_nop 0
    v_add_f32 v8, 1.0, v8
    v_rcp_f32 v8, v8
    s_nop 0
    v_mul_f32 v6, v6, v8
    v_mul_f32 v9, 0xbfb8aa3b, v7
    v_exp_f32 v9, v9
    s_nop 0
    v_add_f32 v9, 1.0, v9
    v_rcp_f32 v9, v9
    s_nop 0
    v_mul_f32 v7, v7, v9
    v_cvt_pk_bf16_f32 v6, v6, v7
    ds_write_b32 v3, v6 offset:1280
    v_lshlrev_b32 v6, 16, v134
    v_and_b32 v7, 0xffff0000, v134
    v_mul_f32 v8, 0xbfb8aa3b, v6
    v_exp_f32 v8, v8
    s_nop 0
    v_add_f32 v8, 1.0, v8
    v_rcp_f32 v8, v8
    s_nop 0
    v_mul_f32 v6, v6, v8
    v_mul_f32 v9, 0xbfb8aa3b, v7
    v_exp_f32 v9, v9
    s_nop 0
    v_add_f32 v9, 1.0, v9
    v_rcp_f32 v9, v9
    s_nop 0
    v_mul_f32 v7, v7, v9
    v_cvt_pk_bf16_f32 v6, v6, v7
    ds_write_b32 v3, v6 offset:1536
    v_lshrrev_b32 v5, 4, v1
    v_lshlrev_b32 v5, 8, v5
    v_and_b32 v6, 15, v1
    v_lshl_add_u32 v5, v6, 3, v5
    v_add_u32 v5, s60, v5
    v_and_b32 v7, 1, v1
    v_mul_u32_u24 v7, 896, v7
    v_lshrrev_b32 v6, 4, v1
    v_lshl_add_u32 v7, v6, 4, v7
    v_add_u32 v7, 159744, v7
    s_lshl_b32 s14, s12, 7
    s_add_u32 s14, s14, 4096
    s_waitcnt vmcnt(0)
    ds_read_b64_tr_b16 v[16:17], v5 offset:0
    ds_read_b64_tr_b16 v[18:19], v5 offset:128
    ds_read_b64_tr_b16 v[20:21], v5 offset:1024
    ds_read_b64_tr_b16 v[22:23], v5 offset:1152
    ds_read_b64_tr_b16 v[24:25], v5 offset:2048
    ds_read_b64_tr_b16 v[26:27], v5 offset:2176
    ds_read_b64_tr_b16 v[28:29], v5 offset:3072
    ds_read_b64_tr_b16 v[30:31], v5 offset:3200
    ds_read_b64_tr_b16 v[32:33], v5 offset:4096
    ds_read_b64_tr_b16 v[34:35], v5 offset:4224
    ds_read_b64_tr_b16 v[36:37], v5 offset:5120
    ds_read_b64_tr_b16 v[38:39], v5 offset:5248
    ds_read_b64_tr_b16 v[40:41], v5 offset:6144
    ds_read_b64_tr_b16 v[42:43], v5 offset:6272
    ds_read_b64_tr_b16 v[44:45], v5 offset:7168
    ds_read_b64_tr_b16 v[46:47], v5 offset:7296
    ds_read_b64_tr_b16 v[48:49], v5 offset:8192
    ds_read_b64_tr_b16 v[50:51], v5 offset:8320
    ds_read_b64_tr_b16 v[52:53], v5 offset:9216
    ds_read_b64_tr_b16 v[54:55], v5 offset:9344
    ds_read_b64_tr_b16 v[56:57], v5 offset:10240
    ds_read_b64_tr_b16 v[58:59], v5 offset:10368
    ds_read_b64_tr_b16 v[60:61], v5 offset:11264
    ds_read_b64_tr_b16 v[62:63], v5 offset:11392
    ds_read_b64_tr_b16 v[64:65], v5 offset:12288
    ds_read_b64_tr_b16 v[66:67], v5 offset:12416
    ds_read_b64_tr_b16 v[68:69], v5 offset:13312
    ds_read_b64_tr_b16 v[70:71], v5 offset:13440
    s_waitcnt lgkmcnt(0)
    ds_read_b128 v[72:75], v7 offset:0
    ds_read_b128 v[76:79], v7 offset:64
    ds_read_b128 v[80:83], v7 offset:128
    ds_read_b128 v[84:87], v7 offset:192
    ds_read_b128 v[88:91], v7 offset:256
    ds_read_b128 v[92:95], v7 offset:320
    ds_read_b128 v[96:99], v7 offset:384
    ds_read_b128 v[100:103], v7 offset:448
    ds_read_b128 v[104:107], v7 offset:512
    ds_read_b128 v[108:111], v7 offset:576
    ds_read_b128 v[112:115], v7 offset:640
    ds_read_b128 v[116:119], v7 offset:704
    ds_read_b128 v[120:123], v7 offset:768
    ds_read_b128 v[124:127], v7 offset:832
    s_waitcnt lgkmcnt(13)
    v_mfma_f32_16x16x32_bf16 v[12:15], v[72:75], v[16:19], 0
    s_waitcnt lgkmcnt(12)
    v_mfma_f32_16x16x32_bf16 v[12:15], v[76:79], v[20:23], v[12:15]
    s_waitcnt lgkmcnt(11)
    v_mfma_f32_16x16x32_bf16 v[12:15], v[80:83], v[24:27], v[12:15]
    s_waitcnt lgkmcnt(10)
    v_mfma_f32_16x16x32_bf16 v[12:15], v[84:87], v[28:31], v[12:15]
    s_waitcnt lgkmcnt(9)
    v_mfma_f32_16x16x32_bf16 v[12:15], v[88:91], v[32:35], v[12:15]
    s_waitcnt lgkmcnt(8)
    v_mfma_f32_16x16x32_bf16 v[12:15], v[92:95], v[36:39], v[12:15]
    s_waitcnt lgkmcnt(7)
    v_mfma_f32_16x16x32_bf16 v[12:15], v[96:99], v[40:43], v[12:15]
    s_waitcnt lgkmcnt(6)
    v_mfma_f32_16x16x32_bf16 v[12:15], v[100:103], v[44:47], v[12:15]
    s_waitcnt lgkmcnt(5)
    v_mfma_f32_16x16x32_bf16 v[12:15], v[104:107], v[48:51], v[12:15]
    s_waitcnt lgkmcnt(4)
    v_mfma_f32_16x16x32_bf16 v[12:15], v[108:111], v[52:55], v[12:15]
    s_waitcnt lgkmcnt(3)
    v_mfma_f32_16x16x32_bf16 v[12:15], v[112:115], v[56:59], v[12:15]
    s_waitcnt lgkmcnt(2)
    v_mfma_f32_16x16x32_bf16 v[12:15], v[116:119], v[60:63], v[12:15]
    s_waitcnt lgkmcnt(1)
    v_mfma_f32_16x16x32_bf16 v[12:15], v[120:123], v[64:67], v[12:15]
    s_waitcnt lgkmcnt(0)
    v_mfma_f32_16x16x32_bf16 v[12:15], v[124:127], v[68:71], v[12:15]
    v_and_b32 v6, 16, v1
    v_cmp_ne_u32 vcc, 0, v6
    s_nop 5
    v_cndmask_b32 v10, v12, v13, vcc
    s_nop 1
    v_mov_b32_dpp v13, v10 quad_perm:[1,0,3,2] row_mask:0xf bank_mask:0xf
    v_cvt_pk_bf16_f32 v13, v10, v13
    v_lshlrev_b32 v6, 4, v1
    v_add_u32 v7, 8, v6
    ds_bpermute_b32 v12, v6, v13
    ds_bpermute_b32 v14, v7, v13
    s_waitcnt lgkmcnt(0)
    v_mov_b32 v13, s11
    v_mov_b32 v15, s11
    s_mov_b32 exec_lo, 0xff
    s_mov_b32 exec_hi, 0
    buffer_store_dwordx4 v[12:15], v6, s[52:55], s14 offen sc1
    s_mov_b64 exec, -1
    s_branch L_hbar2
L_h0late:
    s_barrier
    s_waitcnt vmcnt(0)
    v_readfirstlane_b32 s11, v135
    s_nop 0
    s_mul_i32 s11, s11, 1664525
    s_add_u32 s11, s11, 1013904223
    v_add_u32 v3, 159744, v3
    v_lshlrev_b32 v6, 16, v128
    v_and_b32 v7, 0xffff0000, v128
    v_mul_f32 v8, 0xbfb8aa3b, v6
    v_exp_f32 v8, v8
    s_nop 0
    v_add_f32 v8, 1.0, v8
    v_rcp_f32 v8, v8
    s_nop 0
    v_mul_f32 v6, v6, v8
    v_mul_f32 v9, 0xbfb8aa3b, v7
    v_exp_f32 v9, v9
    s_nop 0
    v_add_f32 v9, 1.0, v9
    v_rcp_f32 v9, v9
    s_nop 0
    v_mul_f32 v7, v7, v9
    v_cvt_pk_bf16_f32 v6, v6, v7
    ds_write_b32 v3, v6 offset:0
    v_lshlrev_b32 v6, 16, v129
    v_and_b32 v7, 0xffff0000, v129
    v_mul_f32 v8, 0xbfb8aa3b, v6
    v_exp_f32 v8, v8
    s_nop 0
    v_add_f32 v8, 1.0, v8
    v_rcp_f32 v8, v8
    s_nop 0
    v_mul_f32 v6, v6, v8
    v_mul_f32 v9, 0xbfb8aa3b, v7
    v_exp_f32 v9, v9
    s_nop 0
    v_add_f32 v9, 1.0, v9
    v_rcp_f32 v9, v9
    s_nop 0
    v_mul_f32 v7, v7, v9
    v_cvt_pk_bf16_f32 v6, v6, v7
    ds_write_b32 v3, v6 offset:256
    v_lshlrev_b32 v6, 16, v130
    v_and_b32 v7, 0xffff0000, v130
    v_mul_f32 v8, 0xbfb8aa3b, v6
    v_exp_f32 v8, v8
    s_nop 0
    v_add_f32 v8, 1.0, v8
    v_rcp_f32 v8, v8
    s_nop 0
    v_mul_f32 v6, v6, v8
    v_mul_f32 v9, 0xbfb8aa3b, v7
    v_exp_f32 v9, v9
    s_nop 0
    v_add_f32 v9, 1.0, v9
    v_rcp_f32 v9, v9
    s_nop 0
    v_mul_f32 v7, v7, v9
    v_cvt_pk_bf16_f32 v6, v6, v7
    ds_write_b32 v3, v6 offset:512
    v_lshlrev_b32 v6, 16, v131
    v_and_b32 v7, 0xffff0000, v131
    v_mul_f32 v8, 0xbfb8aa3b, v6
    v_exp_f32 v8, v8
    s_nop 0
    v_add_f32 v8, 1.0, v8
    v_rcp_f32 v8, v8
    s_nop 0
    v_mul_f32 v6, v6, v8
    v_mul_f32 v9, 0xbfb8aa3b, v7
    v_exp_f32 v9, v9
    s_nop 0
    v_add_f32 v9, 1.0, v9
    v_rcp_f32 v9, v9
    s_nop 0
    v_mul_f32 v7, v7, v9
    v_cvt_pk_bf16_f32 v6, v6, v7
    ds_write_b32 v3, v6 offset:768
    v_lshlrev_b32 v6, 16, v132
    v_and_b32 v7, 0xffff0000, v132
    v_mul_f32 v8, 0xbfb8aa3b, v6
    v_exp_f32 v8, v8
    s_nop 0
    v_add_f32 v8, 1.0, v8
    v_rcp_f32 v8, v8
    s_nop 0
    v_mul_f32 v6, v6, v8
    v_mul_f32 v9, 0xbfb8aa3b, v7
    v_exp_f32 v9, v9
    s_nop 0
    v_add_f32 v9, 1.0, v9
    v_rcp_f32 v9, v9
    s_nop 0
    v_mul_f32 v7, v7, v9
    v_cvt_pk_bf16_f32 v6, v6, v7
    ds_write_b32 v3, v6 offset:1024
    v_lshlrev_b32 v6, 16, v133
    v_and_b32 v7, 0xffff0000, v133
    v_mul_f32 v8, 0xbfb8aa3b, v6
    v_exp_f32 v8, v8
    s_nop 0
    v_add_f32 v8, 1.0, v8
    v_rcp_f32 v8, v8
    s_nop 0
    v_mul_f32 v6, v6, v8
    v_mul_f32 v9, 0xbfb8aa3b, v7
    v_exp_f32 v9, v9
    s_nop 0
    v_add_f32 v9, 1.0, v9
    v_rcp_f32 v9, v9
    s_nop 0
    v_mul_f32 v7, v7, v9
    v_cvt_pk_bf16_f32 v6, v6, v7
    ds_write_b32 v3, v6 offset:1280
    v_lshlrev_b32 v6, 16, v134
    v_and_b32 v7, 0xffff0000, v134
    v_mul_f32 v8, 0xbfb8aa3b, v6
    v_exp_f32 v8, v8
    s_nop 0
    v_add_f32 v8, 1.0, v8
    v_rcp_f32 v8, v8
    s_nop 0
    v_mul_f32 v6, v6, v8
    v_mul_f32 v9, 0xbfb8aa3b, v7
    v_exp_f32 v9, v9
    s_nop 0
    v_add_f32 v9, 1.0, v9
    v_rcp_f32 v9, v9
    s_nop 0
    v_mul_f32 v7, v7, v9
    v_cvt_pk_bf16_f32 v6, v6, v7
    ds_write_b32 v3, v6 offset:1536
    v_lshrrev_b32 v4, 2, v1
    v_mul_u32_u24 v4, 5376, v4
    v_lshrrev_b32 v5, 3, v1
    v_and_b32 v5, 2, v5
    v_xor_b32 v5, v5, v1
    v_and_b32 v5, 3, v5
    v_lshl_add_u32 v4, v5, 4, v4
    s_lshl_b32 s12, s10, 2
    s_add_u32 s12, s12, s9
    s_sub_u32 s12, s12, 28
    s_lshl_b32 s14, s12, 6
    v_lshrrev_b32 v10, 2, v1
    v_lshlrev_b32 v10, 6, v10
    v_and_b32 v6, 3, v1
    v_lshl_add_u32 v10, v6, 3, v10
    v_and_b32 v6, 16, v1
    v_lshl_add_u32 v10, v6, 1, v10
    v_add_u32 v10, s60, v10
    v_xor_b32 v11, 32, v10
    v_and_b32 v9, 1, v1
    v_mul_u32_u24 v9, 896, v9
    v_lshrrev_b32 v6, 4, v1
    v_lshl_add_u32 v9, v6, 3, v9
    v_add_u32 v9, 159744, v9
    s_mov_b32 s15, 262136
    v_mov_b32 v6, 163464
Lw_1:
    ds_read_b32 v7, v6
    s_waitcnt lgkmcnt(0)
    v_readfirstlane_b32 s13, v7
    s_nop 0
    s_cmp_ge_u32 s13, 4
    s_nop 1
    s_cbranch_scc1 Lwd_2
    s_sleep 2
    s_sub_u32 s15, s15, 1
    s_cmp_lg_u32 s15, 0
    s_cbranch_scc1 Lw_1
Lwd_2:
    s_add_u32 s13, s14, 0
    s_add_u32 m0, s60, 0
    s_nop 0
    buffer_load_dwordx4 v4, s[56:59], s13 offen nt lds
    s_add_u32 s13, s14, 86016
    s_add_u32 m0, s60, 1024
    s_nop 0
    buffer_load_dwordx4 v4, s[56:59], s13 offen nt lds
    s_add_u32 s13, s14, 172032
    s_add_u32 m0, s60, 2048
    s_nop 0
    buffer_load_dwordx4 v4, s[56:59], s13 offen nt lds
    s_add_u32 s13, s14, 258048
    s_add_u32 m0, s60, 3072
    s_nop 0
    buffer_load_dwordx4 v4, s[56:59], s13 offen nt lds
    s_add_u32 s13, s14, 344064
    s_add_u32 m0, s60, 4096
    s_nop 0
    buffer_load_dwordx4 v4, s[56:59], s13 offen nt lds
    s_add_u32 s13, s14, 430080
    s_add_u32 m0, s60, 5120
    s_nop 0
    buffer_load_dwordx4 v4, s[56:59], s13 offen nt lds
    s_waitcnt vmcnt(0)
    s_add_u32 s61, s60, 6144
    s_add_u32 s13, s14, 516096
    s_add_u32 m0, s61, 0
    s_nop 0
    buffer_load_dwordx4 v4, s[56:59], s13 offen nt lds
    s_add_u32 s13, s14, 602112
    s_add_u32 m0, s61, 1024
    s_nop 0
    buffer_load_dwordx4 v4, s[56:59], s13 offen nt lds
    s_add_u32 s13, s14, 688128
    s_add_u32 m0, s61, 2048
    s_nop 0
    buffer_load_dwordx4 v4, s[56:59], s13 offen nt lds
    s_add_u32 s13, s14, 774144
    s_add_u32 m0, s61, 3072
    s_nop 0
    buffer_load_dwordx4 v4, s[56:59], s13 offen nt lds
    s_add_u32 s13, s14, 860160
    s_add_u32 m0, s61, 4096
    s_nop 0
    buffer_load_dwordx4 v4, s[56:59], s13 offen nt lds
    s_add_u32 s13, s14, 946176
    s_add_u32 m0, s61, 5120
    s_nop 0
    buffer_load_dwordx4 v4, s[56:59], s13 offen nt lds
    s_add_u32 s13, s14, 1032192
    s_add_u32 m0, s61, 6144
    s_nop 0
    buffer_load_dwordx4 v4, s[56:59], s13 offen nt lds
    s_add_u32 s13, s14, 1118208
    s_add_u32 m0, s61, 7168
    s_nop 0
    buffer_load_dwordx4 v4, s[56:59], s13 offen nt lds
    s_waitcnt vmcnt(0)
    ds_read_b64_tr_b16 v[16:17], v10 offset:0
    ds_read_b64_tr_b16 v[18:19], v10 offset:1024
    ds_read_b64_tr_b16 v[20:21], v11 offset:0
    ds_read_b64_tr_b16 v[22:23], v11 offset:1024
    ds_read_b64_tr_b16 v[24:25], v10 offset:2048
    ds_read_b64_tr_b16 v[26:27], v10 offset:3072
    ds_read_b64_tr_b16 v[28:29], v11 offset:2048
    ds_read_b64_tr_b16 v[30:31], v11 offset:3072
    ds_read_b64_tr_b16 v[32:33], v10 offset:4096
    ds_read_b64_tr_b16 v[34:35], v10 offset:5120
    ds_read_b64_tr_b16 v[36:37], v11 offset:4096
    ds_read_b64_tr_b16 v[38:39], v11 offset:5120
    ds_read_b64_tr_b16 v[40:41], v10 offset:6144
    ds_read_b64_tr_b16 v[42:43], v10 offset:7168
    ds_read_b64_tr_b16 v[44:45], v11 offset:6144
    ds_read_b64_tr_b16 v[46:47], v11 offset:7168
    ds_read_b64_tr_b16 v[48:49], v10 offset:8192
    ds_read_b64_tr_b16 v[50:51], v10 offset:9216
    ds_read_b64_tr_b16 v[52:53], v11 offset:8192
    ds_read_b64_tr_b16 v[54:55], v11 offset:9216
    ds_read_b64_tr_b16 v[56:57], v10 offset:10240
    ds_read_b64_tr_b16 v[58:59], v10 offset:11264
    ds_read_b64_tr_b16 v[60:61], v11 offset:10240
    ds_read_b64_tr_b16 v[62:63], v11 offset:11264
    ds_read_b64_tr_b16 v[64:65], v10 offset:12288
    ds_read_b64_tr_b16 v[66:67], v10 offset:13312
    ds_read_b64_tr_b16 v[68:69], v11 offset:12288
    ds_read_b64_tr_b16 v[70:71], v11 offset:13312
    s_waitcnt lgkmcnt(0)
    ds_read2_b64 v[72:75], v9 offset0:0 offset1:4
    ds_read2_b64 v[76:79], v9 offset0:8 offset1:12
    ds_read2_b64 v[80:83], v9 offset0:16 offset1:20
    ds_read2_b64 v[84:87], v9 offset0:24 offset1:28
    ds_read2_b64 v[88:91], v9 offset0:32 offset1:36
    ds_read2_b64 v[92:95], v9 offset0:40 offset1:44
    ds_read2_b64 v[96:99], v9 offset0:48 offset1:52
    s_waitcnt lgkmcnt(6)
    v_mfma_f32_16x16x32_bf16 v[128:131], v[72:75], v[16:19], 0
    v_mfma_f32_16x16x32_bf16 v[132:135], v[72:75], v[20:23], 0
    s_waitcnt lgkmcnt(5)
    v_mfma_f32_16x16x32_bf16 v[128:131], v[76:79], v[24:27], v[128:131]
    v_mfma_f32_16x16x32_bf16 v[132:135], v[76:79], v[28:31], v[132:135]
    s_waitcnt lgkmcnt(4)
    v_mfma_f32_16x16x32_bf16 v[128:131], v[80:83], v[32:35], v[128:131]
    v_mfma_f32_16x16x32_bf16 v[132:135], v[80:83], v[36:39], v[132:135]
    s_waitcnt lgkmcnt(3)
    v_mfma_f32_16x16x32_bf16 v[128:131], v[84:87], v[40:43], v[128:131]
    v_mfma_f32_16x16x32_bf16 v[132:135], v[84:87], v[44:47], v[132:135]
    s_waitcnt lgkmcnt(2)
    v_mfma_f32_16x16x32_bf16 v[128:131], v[88:91], v[48:51], v[128:131]
    v_mfma_f32_16x16x32_bf16 v[132:135], v[88:91], v[52:55], v[132:135]
    s_waitcnt lgkmcnt(1)
    v_mfma_f32_16x16x32_bf16 v[128:131], v[92:95], v[56:59], v[128:131]
    v_mfma_f32_16x16x32_bf16 v[132:135], v[92:95], v[60:63], v[132:135]
    s_waitcnt lgkmcnt(0)
    v_mfma_f32_16x16x32_bf16 v[128:131], v[96:99], v[64:67], v[128:131]
    v_mfma_f32_16x16x32_bf16 v[132:135], v[96:99], v[68:71], v[132:135]
    s_add_u32 s13, s14, 1204224
    s_add_u32 m0, s60, 0
    s_nop 0
    buffer_load_dwordx4 v4, s[56:59], s13 offen nt lds
    s_add_u32 s13, s14, 1290240
    s_add_u32 m0, s60, 1024
    s_nop 0
    buffer_load_dwordx4 v4, s[56:59], s13 offen nt lds
    s_add_u32 s13, s14, 1376256
    s_add_u32 m0, s60, 2048
    s_nop 0
    buffer_load_dwordx4 v4, s[56:59], s13 offen nt lds
    s_add_u32 s13, s14, 1462272
    s_add_u32 m0, s60, 3072
    s_nop 0
    buffer_load_dwordx4 v4, s[56:59], s13 offen nt lds
    s_add_u32 s13, s14, 1548288
    s_add_u32 m0, s60, 4096
    s_nop 0
    buffer_load_dwordx4 v4, s[56:59], s13 offen nt lds
    s_add_u32 s13, s14, 1634304
    s_add_u32 m0, s60, 5120
    s_nop 0
    buffer_load_dwordx4 v4, s[56:59], s13 offen nt lds
    s_waitcnt vmcnt(0)
    s_add_u32 s61, s60, 6144
    s_add_u32 s13, s14, 1720320
    s_add_u32 m0, s61, 0
    s_nop 0
    buffer_load_dwordx4 v4, s[56:59], s13 offen nt lds
    s_add_u32 s13, s14, 1806336
    s_add_u32 m0, s61, 1024
    s_nop 0
    buffer_load_dwordx4 v4, s[56:59], s13 offen nt lds
    s_add_u32 s13, s14, 1892352
    s_add_u32 m0, s61, 2048
    s_nop 0
    buffer_load_dwordx4 v4, s[56:59], s13 offen nt lds
    s_add_u32 s13, s14, 1978368
    s_add_u32 m0, s61, 3072
    s_nop 0
    buffer_load_dwordx4 v4, s[56:59], s13 offen nt lds
    s_add_u32 s13, s14, 2064384
    s_add_u32 m0, s61, 4096
    s_nop 0
    buffer_load_dwordx4 v4, s[56:59], s13 offen nt lds
    s_add_u32 s13, s14, 2150400
    s_add_u32 m0, s61, 5120
    s_nop 0
    buffer_load_dwordx4 v4, s[56:59], s13 offen nt lds
    s_add_u32 s13, s14, 2236416
    s_add_u32 m0, s61, 6144
    s_nop 0
    buffer_load_dwordx4 v4, s[56:59], s13 offen nt lds
    s_add_u32 s13, s14, 2322432
    s_add_u32 m0, s61, 7168
    s_nop 0
    buffer_load_dwordx4 v4, s[56:59], s13 offen nt lds
    s_waitcnt vmcnt(0)
    ds_read_b64_tr_b16 v[16:17], v10 offset:0
    ds_read_b64_tr_b16 v[18:19], v10 offset:1024
    ds_read_b64_tr_b16 v[20:21], v11 offset:0
    ds_read_b64_tr_b16 v[22:23], v11 offset:1024
    ds_read_b64_tr_b16 v[24:25], v10 offset:2048
    ds_read_b64_tr_b16 v[26:27], v10 offset:3072
    ds_read_b64_tr_b16 v[28:29], v11 offset:2048
    ds_read_b64_tr_b16 v[30:31], v11 offset:3072
    ds_read_b64_tr_b16 v[32:33], v10 offset:4096
    ds_read_b64_tr_b16 v[34:35], v10 offset:5120
    ds_read_b64_tr_b16 v[36:37], v11 offset:4096
    ds_read_b64_tr_b16 v[38:39], v11 offset:5120
    ds_read_b64_tr_b16 v[40:41], v10 offset:6144
    ds_read_b64_tr_b16 v[42:43], v10 offset:7168
    ds_read_b64_tr_b16 v[44:45], v11 offset:6144
    ds_read_b64_tr_b16 v[46:47], v11 offset:7168
    ds_read_b64_tr_b16 v[48:49], v10 offset:8192
    ds_read_b64_tr_b16 v[50:51], v10 offset:9216
    ds_read_b64_tr_b16 v[52:53], v11 offset:8192
    ds_read_b64_tr_b16 v[54:55], v11 offset:9216
    ds_read_b64_tr_b16 v[56:57], v10 offset:10240
    ds_read_b64_tr_b16 v[58:59], v10 offset:11264
    ds_read_b64_tr_b16 v[60:61], v11 offset:10240
    ds_read_b64_tr_b16 v[62:63], v11 offset:11264
    ds_read_b64_tr_b16 v[64:65], v10 offset:12288
    ds_read_b64_tr_b16 v[66:67], v10 offset:13312
    ds_read_b64_tr_b16 v[68:69], v11 offset:12288
    ds_read_b64_tr_b16 v[70:71], v11 offset:13312
    s_waitcnt lgkmcnt(0)
    ds_read2_b64 v[72:75], v9 offset0:56 offset1:60
    ds_read2_b64 v[76:79], v9 offset0:64 offset1:68
    ds_read2_b64 v[80:83], v9 offset0:72 offset1:76
    ds_read2_b64 v[84:87], v9 offset0:80 offset1:84
    ds_read2_b64 v[88:91], v9 offset0:88 offset1:92
    ds_read2_b64 v[92:95], v9 offset0:96 offset1:100
    ds_read2_b64 v[96:99], v9 offset0:104 offset1:108
    s_waitcnt lgkmcnt(6)
    v_mfma_f32_16x16x32_bf16 v[128:131], v[72:75], v[16:19], v[128:131]
    v_mfma_f32_16x16x32_bf16 v[132:135], v[72:75], v[20:23], v[132:135]
    s_waitcnt lgkmcnt(5)
    v_mfma_f32_16x16x32_bf16 v[128:131], v[76:79], v[24:27], v[128:131]
    v_mfma_f32_16x16x32_bf16 v[132:135], v[76:79], v[28:31], v[132:135]
    s_waitcnt lgkmcnt(4)
    v_mfma_f32_16x16x32_bf16 v[128:131], v[80:83], v[32:35], v[128:131]
    v_mfma_f32_16x16x32_bf16 v[132:135], v[80:83], v[36:39], v[132:135]
    s_waitcnt lgkmcnt(3)
    v_mfma_f32_16x16x32_bf16 v[128:131], v[84:87], v[40:43], v[128:131]
    v_mfma_f32_16x16x32_bf16 v[132:135], v[84:87], v[44:47], v[132:135]
    s_waitcnt lgkmcnt(2)
    v_mfma_f32_16x16x32_bf16 v[128:131], v[88:91], v[48:51], v[128:131]
    v_mfma_f32_16x16x32_bf16 v[132:135], v[88:91], v[52:55], v[132:135]
    s_waitcnt lgkmcnt(1)
    v_mfma_f32_16x16x32_bf16 v[128:131], v[92:95], v[56:59], v[128:131]
    v_mfma_f32_16x16x32_bf16 v[132:135], v[92:95], v[60:63], v[132:135]
    s_waitcnt lgkmcnt(0)
    v_mfma_f32_16x16x32_bf16 v[128:131], v[96:99], v[64:67], v[128:131]
    v_mfma_f32_16x16x32_bf16 v[132:135], v[96:99], v[68:71], v[132:135]
    s_lshl_b32 s14, s12, 8
    s_add_u32 s14, s14, 4096
    v_and_b32 v6, 16, v1
    v_cmp_ne_u32 vcc, 0, v6
    s_nop 2
    v_cndmask_b32 v10, v128, v129, vcc
    v_cndmask_b32 v6, v132, v133, vcc
    v_cmp_lt_u32 vcc, 31, v1
    s_nop 1
    v_cndmask_b32 v10, v10, v6, vcc
    s_nop 1
    v_mov_b32_dpp v13, v10 quad_perm:[1,0,3,2] row_mask:0xf bank_mask:0xf
    v_cvt_pk_bf16_f32 v13, v10, v13
    v_lshlrev_b32 v6, 4, v1
    v_add_u32 v7, 8, v6
    ds_bpermute_b32 v12, v6, v13
    ds_bpermute_b32 v14, v7, v13
    s_waitcnt lgkmcnt(0)
    v_mov_b32 v13, s11
    v_mov_b32 v15, s11
    s_mov_b32 exec_lo, 0xffff
    s_mov_b32 exec_hi, 0
    buffer_store_dwordx4 v[12:15], v6, s[52:55], s14 offen sc1
    s_mov_b64 exec, -1
    s_branch L_hbar2
L_h1:
    s_mov_b32 s64, s16
    s_mov_b32 s65, s17
    s_mov_b32 s66, 1792
    s_mov_b32 s67, 0x20000
    s_mov_b32 s56, s22
    s_mov_b32 s57, s23
    s_mov_b32 s58, 3670016
    s_mov_b32 s59, 0x20000
    v_lshrrev_b32 v10, 5, v1
    v_and_b32 v11, 31, v1
    v_mul_u32_u24 v3, 224, v10
    v_add_u32 v4, v3, v11
    v_lshlrev_b32 v4, 2, v4
    buffer_load_dword v128, v4, s[64:67], 0 offen offset:0
    buffer_load_dword v129, v4, s[64:67], 0 offen offset:128
    buffer_load_dword v130, v4, s[64:67], 0 offen offset:256
    buffer_load_dword v131, v4, s[64:67], 0 offen offset:384
    buffer_load_dword v132, v4, s[64:67], 0 offen offset:512
    buffer_load_dword v133, v4, s[64:67], 0 offen offset:640
    buffer_load_dword v134, v4, s[64:67], 0 offen offset:768
    buffer_load_dword v135, v2, s[52:55], 0 offen sc1
    s_lshr_b32 s61, s5, 1
    s_and_b32 s61, s61, 1
    v_and_b32 v12, 15, v1
    v_add_u32 v5, v3, v12
    v_lshlrev_b32 v5, 2, v5
    s_mul_i32 s14, s61, 448
    buffer_load_dword v152, v4, s[64:67], s14 offen offset:0
    buffer_load_dword v153, v4, s[64:67], s14 offen offset:128
    buffer_load_dword v154, v4, s[64:67], s14 offen offset:256
    buffer_load_dword v155, v5, s[64:67], s14 offen offset:384
    v_lshrrev_b32 v4, 2, v1
    v_mul_u32_u24 v4, 8192, v4
    v_lshrrev_b32 v5, 3, v1
    v_and_b32 v5, 2, v5
    v_xor_b32 v5, v5, v1
    v_and_b32 v5, 3, v5
    v_lshl_add_u32 v4, v5, 4, v4
    s_lshl_b32 s12, s4, 4
    s_lshl_b32 s13, s8, 1
    s_add_u32 s12, s12, s13
    s_and_b32 s13, s5, 1
    s_add_u32 s12, s12, s13
    s_lshl_b32 s14, s12, 6
    s_mul_i32 s13, s61, 1835008
    s_add_u32 s14, s14, s13
    s_mov_b32 s60, 145408
    s_barrier
    s_waitcnt vmcnt(0)
    s_add_u32 s13, s14, 0
    s_add_u32 m0, s60, 0
    s_nop 0
    buffer_load_dwordx4 v4, s[56:59], s13 offen nt lds
    s_add_u32 s13, s14, 131072
    s_add_u32 m0, s60, 1024
    s_nop 0
    buffer_load_dwordx4 v4, s[56:59], s13 offen nt lds
    s_add_u32 s13, s14, 262144
    s_add_u32 m0, s60, 2048
    s_nop 0
    buffer_load_dwordx4 v4, s[56:59], s13 offen nt lds
    s_add_u32 s13, s14, 393216
    s_add_u32 m0, s60, 3072
    s_nop 0
    buffer_load_dwordx4 v4, s[56:59], s13 offen nt lds
    s_add_u32 s13, s14, 524288
    s_add_u32 m0, s60, 4096
    s_nop 0
    buffer_load_dwordx4 v4, s[56:59], s13 offen nt lds
    s_add_u32 s13, s14, 655360
    s_add_u32 m0, s60, 5120
    s_nop 0
    buffer_load_dwordx4 v4, s[56:59], s13 offen nt lds
    s_add_u32 s13, s14, 786432
    s_add_u32 m0, s60, 6144
    s_nop 0
    buffer_load_dwordx4 v4, s[56:59], s13 offen nt lds
    s_add_u32 s13, s14, 917504
    s_add_u32 m0, s60, 7168
    s_nop 0
    buffer_load_dwordx4 v4, s[56:59], s13 offen nt lds
    s_add_u32 s13, s14, 1048576
    s_add_u32 m0, s60, 8192
    s_nop 0
    buffer_load_dwordx4 v4, s[56:59], s13 offen nt lds
    s_add_u32 s13, s14, 1179648
    s_add_u32 m0, s60, 9216
    s_nop 0
    buffer_load_dwordx4 v4, s[56:59], s13 offen nt lds
    s_add_u32 s13, s14, 1310720
    s_add_u32 m0, s60, 10240
    s_nop 0
    buffer_load_dwordx4 v4, s[56:59], s13 offen nt lds
    s_add_u32 s13, s14, 1441792
    s_add_u32 m0, s60, 11264
    s_nop 0
    buffer_load_dwordx4 v4, s[56:59], s13 offen nt lds
    s_add_u32 s13, s14, 1572864
    s_add_u32 m0, s60, 12288
    s_nop 0
    buffer_load_dwordx4 v4, s[56:59], s13 offen nt lds
    s_add_u32 s13, s14, 1703936
    s_add_u32 m0, s60, 13312
    s_nop 0
    buffer_load_dwordx4 v4, s[56:59], s13 offen nt lds
    v_readfirstlane_b32 s11, v135
    s_nop 0
    s_mul_i32 s11, s11, 1664525
    s_add_u32 s11, s11, 1013904223
    v_lshlrev_b32 v136, 16, v128
    v_and_b32 v137, 0xffff0000, v128
    v_lshlrev_b32 v138, 16, v129
    v_and_b32 v139, 0xffff0000, v129
    v_lshlrev_b32 v140, 16, v130
    v_and_b32 v141, 0xffff0000, v130
    v_lshlrev_b32 v142, 16, v131
    v_and_b32 v143, 0xffff0000, v131
    v_lshlrev_b32 v144, 16, v132
    v_and_b32 v145, 0xffff0000, v132
    v_lshlrev_b32 v146, 16, v133
    v_and_b32 v147, 0xffff0000, v133
    v_lshlrev_b32 v148, 16, v134
    v_and_b32 v149, 0xffff0000, v134
    v_add_f32 v6, v136, v137
    v_add_f32 v6, v6, v138
    v_add_f32 v6, v6, v139
    v_add_f32 v6, v6, v140
    v_add_f32 v6, v6, v141
    v_add_f32 v6, v6, v142
    v_add_f32 v6, v6, v143
    v_add_f32 v6, v6, v144
    v_add_f32 v6, v6, v145
    v_add_f32 v6, v6, v146
    v_add_f32 v6, v6, v147
    v_add_f32 v6, v6, v148
    v_add_f32 v6, v6, v149
    s_nop 1
    v_add_f32_dpp v6, v6, v6 quad_perm:[1,0,3,2] row_mask:0xf bank_mask:0xf
    s_nop 1
    v_add_f32_dpp v6, v6, v6 quad_perm:[2,3,0,1] row_mask:0xf bank_mask:0xf
    s_nop 1
    v_add_f32_dpp v6, v6, v6 row_half_mirror row_mask:0xf bank_mask:0xf
    s_nop 1
    v_add_f32_dpp v6, v6, v6 row_mirror row_mask:0xf bank_mask:0xf
    v_mov_b32 v7, v6
    s_nop 1
    v_permlane16_swap_b32 v6, v7
    v_add_f32 v6, v6, v7
    v_mul_f32 v6, 0x3b124925, v6
    v_mov_b32 v8, 0
    v_sub_f32 v7, v136, v6
    v_fmac_f32 v8, v7, v7
    v_sub_f32 v7, v137, v6
    v_fmac_f32 v8, v7, v7
    v_sub_f32 v7, v138, v6
    v_fmac_f32 v8, v7, v7
    v_sub_f32 v7, v139, v6
    v_fmac_f32 v8, v7, v7
    v_sub_f32 v7, v140, v6
    v_fmac_f32 v8, v7, v7
    v_sub_f32 v7, v141, v6
    v_fmac_f32 v8, v7, v7
    v_sub_f32 v7, v142, v6
    v_fmac_f32 v8, v7, v7
    v_sub_f32 v7, v143, v6
    v_fmac_f32 v8, v7, v7
    v_sub_f32 v7, v144, v6
    v_fmac_f32 v8, v7, v7
    v_sub_f32 v7, v145, v6
    v_fmac_f32 v8, v7, v7
    v_sub_f32 v7, v146, v6
    v_fmac_f32 v8, v7, v7
    v_sub_f32 v7, v147, v6
    v_fmac_f32 v8, v7, v7
    v_sub_f32 v7, v148, v6
    v_fmac_f32 v8, v7, v7
    v_sub_f32 v7, v149, v6
    v_fmac_f32 v8, v7, v7
    s_nop 1
    v_add_f32_dpp v8, v8, v8 quad_perm:[1,0,3,2] row_mask:0xf bank_mask:0xf
    s_nop 1
    v_add_f32_dpp v8, v8, v8 quad_perm:[2,3,0,1] row_mask:0xf bank_mask:0xf
    s_nop 1
    v_add_f32_dpp v8, v8, v8 row_half_mirror row_mask:0xf bank_mask:0xf
    s_nop 1
    v_add_f32_dpp v8, v8, v8 row_mirror row_mask:0xf bank_mask:0xf
    v_mov_b32 v7, v8
    s_nop 1
    v_permlane16_swap_b32 v8, v7
    v_add_f32 v8, v8, v7
    v_mul_f32 v8, 0x3b124925, v8
    v_cvt_pk_bf16_f32 v6, v6, v6
    v_lshlrev_b32 v6, 16, v6
    v_cvt_pk_bf16_f32 v8, v8, v8
    v_lshlrev_b32 v8, 16, v8
    v_add_f32 v8, 0x3727c5ac, v8
    v_cvt_pk_bf16_f32 v8, v8, v8
    v_lshlrev_b32 v8, 16, v8
    v_sqrt_f32 v8, v8
    s_nop 0
    v_cvt_pk_bf16_f32 v8, v8, v8
    v_lshlrev_b32 v8, 16, v8
    v_rcp_f32 v8, v8
    v_lshlrev_b32 v136, 16, v152
    v_and_b32 v137, 0xffff0000, v152
    v_sub_f32 v136, v136, v6
    v_sub_f32 v137, v137, v6
    v_cvt_pk_bf16_f32 v7, v136, v137
    v_lshlrev_b32 v136, 16, v7
    v_and_b32 v137, 0xffff0000, v7
    v_mul_f32 v136, v136, v8
    v_mul_f32 v137, v137, v8
    v_cvt_pk_bf16_f32 v7, v136, v137
    v_lshlrev_b32 v136, 16, v7
    v_and_b32 v137, 0xffff0000, v7
    v_lshlrev_b32 v138, 16, v153
    v_and_b32 v139, 0xffff0000, v153
    v_sub_f32 v138, v138, v6
    v_sub_f32 v139, v139, v6
    v_cvt_pk_bf16_f32 v7, v138, v139
    v_lshlrev_b32 v138, 16, v7
    v_and_b32 v139, 0xffff0000, v7
    v_mul_f32 v138, v138, v8
    v_mul_f32 v139, v139, v8
    v_cvt_pk_bf16_f32 v7, v138, v139
    v_lshlrev_b32 v138, 16, v7
    v_and_b32 v139, 0xffff0000, v7
    v_lshlrev_b32 v140, 16, v154
    v_and_b32 v141, 0xffff0000, v154
    v_sub_f32 v140, v140, v6
    v_sub_f32 v141, v141, v6
    v_cvt_pk_bf16_f32 v7, v140, v141
    v_lshlrev_b32 v140, 16, v7
    v_and_b32 v141, 0xffff0000, v7
    v_mul_f32 v140, v140, v8
    v_mul_f32 v141, v141, v8
    v_cvt_pk_bf16_f32 v7, v140, v141
    v_lshlrev_b32 v140, 16, v7
    v_and_b32 v141, 0xffff0000, v7
    v_lshlrev_b32 v142, 16, v155
    v_and_b32 v143, 0xffff0000, v155
    v_sub_f32 v142, v142, v6
    v_sub_f32 v143, v143, v6
    v_cvt_pk_bf16_f32 v7, v142, v143
    v_lshlrev_b32 v142, 16, v7
    v_and_b32 v143, 0xffff0000, v7
    v_mul_f32 v142, v142, v8
    v_mul_f32 v143, v143, v8
    v_cvt_pk_bf16_f32 v7, v142, v143
    v_lshlrev_b32 v142, 16, v7
    v_and_b32 v143, 0xffff0000, v7
    v_lshrrev_b32 v8, 2, v1
    v_lshlrev_b32 v8, 6, v8
    v_and_b32 v6, 3, v1
    v_lshl_add_u32 v8, v6, 3, v8
    v_and_b32 v6, 16, v1
    v_lshl_add_u32 v8, v6, 1, v8
    v_add_u32 v8, s60, v8
    v_xor_b32 v9, 32, v8
    v_and_b32 v6, 7, v1
    v_lshlrev_b32 v6, 3, v6
    v_lshl_add_u32 v6, v10, 6, v6
    v_lshrrev_b32 v4, 3, v11
    v_lshl_add_u32 v4, v4, 7, v6
    v_lshrrev_b32 v5, 3, v12
    v_lshl_add_u32 v5, v5, 7, v6
    s_mul_i32 s14, s61, 1792
    s_add_u32 s14, s14, 4096
    s_add_u32 s63, s14, 3584
    v_mul_u32_u24 v13, 448, v10
    v_add_u32 v13, 161536, v13
    v_lshl_add_u32 v3, v11, 2, v13
    v_lshl_add_u32 v13, v12, 2, v13
    s_waitcnt vmcnt(0)
    ds_read_b64_tr_b16 v[16:17], v8 offset:0
    ds_read_b64_tr_b16 v[18:19], v8 offset:1024
    ds_read_b64_tr_b16 v[20:21], v9 offset:0
    ds_read_b64_tr_b16 v[22:23], v9 offset:1024
    ds_read_b64_tr_b16 v[24:25], v8 offset:2048
    ds_read_b64_tr_b16 v[26:27], v8 offset:3072
    ds_read_b64_tr_b16 v[28:29], v9 offset:2048
    ds_read_b64_tr_b16 v[30:31], v9 offset:3072
    ds_read_b64_tr_b16 v[32:33], v8 offset:4096
    ds_read_b64_tr_b16 v[34:35], v8 offset:5120
    ds_read_b64_tr_b16 v[36:37], v9 offset:4096
    ds_read_b64_tr_b16 v[38:39], v9 offset:5120
    ds_read_b64_tr_b16 v[40:41], v8 offset:6144
    ds_read_b64_tr_b16 v[42:43], v8 offset:7168
    ds_read_b64_tr_b16 v[44:45], v9 offset:6144
    ds_read_b64_tr_b16 v[46:47], v9 offset:7168
    ds_read_b64_tr_b16 v[48:49], v8 offset:8192
    ds_read_b64_tr_b16 v[50:51], v8 offset:9216
    ds_read_b64_tr_b16 v[52:53], v9 offset:8192
    ds_read_b64_tr_b16 v[54:55], v9 offset:9216
    ds_read_b64_tr_b16 v[56:57], v8 offset:10240
    ds_read_b64_tr_b16 v[58:59], v8 offset:11264
    ds_read_b64_tr_b16 v[60:61], v9 offset:10240
    ds_read_b64_tr_b16 v[62:63], v9 offset:11264
    ds_read_b64_tr_b16 v[64:65], v8 offset:12288
    ds_read_b64_tr_b16 v[66:67], v8 offset:13312
    ds_read_b64_tr_b16 v[68:69], v9 offset:12288
    ds_read_b64_tr_b16 v[70:71], v9 offset:13312
    s_cmp_lt_u32 s10, 14
    s_cselect_b32 s62, 11, 15
    s_mov_b32 s15, 262136
    v_mov_b32 v6, 163464
Lw_3:
    ds_read_b32 v7, v6
    s_waitcnt lgkmcnt(0)
    v_readfirstlane_b32 s13, v7
    s_nop 0
    s_cmp_ge_u32 s13, s62
    s_nop 1
    s_cbranch_scc1 Lwd_4
    s_sleep 2
    s_sub_u32 s15, s15, 1
    s_cmp_lg_u32 s15, 0
    s_cbranch_scc1 Lw_3
Lwd_4:
    s_mov_b32 s15, 32767
Lpoll_5:
    buffer_load_dwordx2 v[72:73], v4, s[52:55], s14 offen offset:0 sc1
    buffer_load_dwordx2 v[74:75], v4, s[52:55], s14 offen offset:512 sc1
    buffer_load_dwordx2 v[76:77], v4, s[52:55], s14 offen offset:1024 sc1
    buffer_load_dwordx2 v[78:79], v5, s[52:55], s14 offen offset:1536 sc1
    buffer_load_dwordx2 v[80:81], v4, s[52:55], s63 offen offset:0 sc1
    buffer_load_dwordx2 v[82:83], v4, s[52:55], s63 offen offset:512 sc1
    buffer_load_dwordx2 v[84:85], v4, s[52:55], s63 offen offset:1024 sc1
    buffer_load_dwordx2 v[86:87], v5, s[52:55], s63 offen offset:1536 sc1
    s_waitcnt vmcnt(0)
    v_xor_b32 v6, s11, v73
    v_bitop3_b32 v6, v6, v75, s11 bitop3:0xf6
    v_bitop3_b32 v6, v6, v77, s11 bitop3:0xf6
    v_bitop3_b32 v6, v6, v79, s11 bitop3:0xf6
    v_bitop3_b32 v6, v6, v81, s11 bitop3:0xf6
    v_bitop3_b32 v6, v6, v83, s11 bitop3:0xf6
    v_bitop3_b32 v6, v6, v85, s11 bitop3:0xf6
    v_bitop3_b32 v6, v6, v87, s11 bitop3:0xf6
    v_cmp_ne_u32 vcc, 0, v6
    s_nop 0
    s_cbranch_vccz Lpolld_6
    s_sleep 8
    s_sub_u32 s15, s15, 1
    s_cmp_lg_u32 s15, 0
    s_cbranch_scc1 Lpoll_5
Lpolld_6:
    v_lshlrev_b32 v6, 16, v80
    v_and_b32 v7, 0xffff0000, v80
    v_add_f32 v6, 1.0, v6
    v_add_f32 v7, 1.0, v7
    v_cvt_pk_bf16_f32 v8, v6, v7
    v_lshlrev_b32 v6, 16, v8
    v_and_b32 v7, 0xffff0000, v8
    v_mul_f32 v136, v136, v6
    v_mul_f32 v137, v137, v7
    v_cvt_pk_bf16_f32 v8, v136, v137
    v_lshlrev_b32 v136, 16, v8
    v_and_b32 v137, 0xffff0000, v8
    v_lshlrev_b32 v6, 16, v72
    v_and_b32 v7, 0xffff0000, v72
    v_add_f32 v136, v136, v6
    v_add_f32 v137, v137, v7
    v_cvt_pk_bf16_f32 v6, v136, v137
    ds_write_b32 v3, v6 offset:0
    v_lshlrev_b32 v6, 16, v82
    v_and_b32 v7, 0xffff0000, v82
    v_add_f32 v6, 1.0, v6
    v_add_f32 v7, 1.0, v7
    v_cvt_pk_bf16_f32 v8, v6, v7
    v_lshlrev_b32 v6, 16, v8
    v_and_b32 v7, 0xffff0000, v8
    v_mul_f32 v138, v138, v6
    v_mul_f32 v139, v139, v7
    v_cvt_pk_bf16_f32 v8, v138, v139
    v_lshlrev_b32 v138, 16, v8
    v_and_b32 v139, 0xffff0000, v8
    v_lshlrev_b32 v6, 16, v74
    v_and_b32 v7, 0xffff0000, v74
    v_add_f32 v138, v138, v6
    v_add_f32 v139, v139, v7
    v_cvt_pk_bf16_f32 v6, v138, v139
    ds_write_b32 v3, v6 offset:128
    v_lshlrev_b32 v6, 16, v84
    v_and_b32 v7, 0xffff0000, v84
    v_add_f32 v6, 1.0, v6
    v_add_f32 v7, 1.0, v7
    v_cvt_pk_bf16_f32 v8, v6, v7
    v_lshlrev_b32 v6, 16, v8
    v_and_b32 v7, 0xffff0000, v8
    v_mul_f32 v140, v140, v6
    v_mul_f32 v141, v141, v7
    v_cvt_pk_bf16_f32 v8, v140, v141
    v_lshlrev_b32 v140, 16, v8
    v_and_b32 v141, 0xffff0000, v8
    v_lshlrev_b32 v6, 16, v76
    v_and_b32 v7, 0xffff0000, v76
    v_add_f32 v140, v140, v6
    v_add_f32 v141, v141, v7
    v_cvt_pk_bf16_f32 v6, v140, v141
    ds_write_b32 v3, v6 offset:256
    v_lshlrev_b32 v6, 16, v86
    v_and_b32 v7, 0xffff0000, v86
    v_add_f32 v6, 1.0, v6
    v_add_f32 v7, 1.0, v7
    v_cvt_pk_bf16_f32 v8, v6, v7
    v_lshlrev_b32 v6, 16, v8
    v_and_b32 v7, 0xffff0000, v8
    v_mul_f32 v142, v142, v6
    v_mul_f32 v143, v143, v7
    v_cvt_pk_bf16_f32 v8, v142, v143
    v_lshlrev_b32 v142, 16, v8
    v_and_b32 v143, 0xffff0000, v8
    v_lshlrev_b32 v6, 16, v78
    v_and_b32 v7, 0xffff0000, v78
    v_add_f32 v142, v142, v6
    v_add_f32 v143, v143, v7
    v_cvt_pk_bf16_f32 v6, v142, v143
    ds_write_b32 v13, v6 offset:384
    v_and_b32 v7, 1, v1
    v_mul_u32_u24 v7, 448, v7
    v_lshrrev_b32 v6, 4, v1
    v_lshl_add_u32 v7, v6, 3, v7
    v_add_u32 v7, 161536, v7
    v_bfe_u32 v8, v1, 3, 1
    v_mul_u32_u24 v8, 32768, v8
    v_and_b32 v6, 7, v1
    v_lshl_add_u32 v8, v6, 4, v8
    v_bfe_u32 v6, v1, 4, 1
    v_lshl_add_u32 v8, v6, 7, v8
    s_lshl_b32 s14, s12, 8
    s_lshl_b32 s13, s61, 16
    s_add_u32 s14, s14, s13
    s_add_u32 s14, s14, 262144
    s_waitcnt lgkmcnt(0)
    ds_read2_b64 v[72:75], v7 offset0:0 offset1:4
    ds_read2_b64 v[76:79], v7 offset0:8 offset1:12
    ds_read2_b64 v[80:83], v7 offset0:16 offset1:20
    ds_read2_b64 v[84:87], v7 offset0:24 offset1:28
    ds_read2_b64 v[88:91], v7 offset0:32 offset1:36
    ds_read2_b64 v[92:95], v7 offset0:40 offset1:44
    ds_read2_b64 v[96:99], v7 offset0:48 offset1:52
    s_waitcnt lgkmcnt(6)
    v_mfma_f32_16x16x32_bf16 v[128:131], v[72:75], v[16:19], 0
    v_mfma_f32_16x16x32_bf16 v[132:135], v[72:75], v[20:23], 0
    s_waitcnt lgkmcnt(5)
    v_mfma_f32_16x16x32_bf16 v[128:131], v[76:79], v[24:27], v[128:131]
    v_mfma_f32_16x16x32_bf16 v[132:135], v[76:79], v[28:31], v[132:135]
    s_waitcnt lgkmcnt(4)
    v_mfma_f32_16x16x32_bf16 v[128:131], v[80:83], v[32:35], v[128:131]
    v_mfma_f32_16x16x32_bf16 v[132:135], v[80:83], v[36:39], v[132:135]
    s_waitcnt lgkmcnt(3)
    v_mfma_f32_16x16x32_bf16 v[128:131], v[84:87], v[40:43], v[128:131]
    v_mfma_f32_16x16x32_bf16 v[132:135], v[84:87], v[44:47], v[132:135]
    s_waitcnt lgkmcnt(2)
    v_mfma_f32_16x16x32_bf16 v[128:131], v[88:91], v[48:51], v[128:131]
    v_mfma_f32_16x16x32_bf16 v[132:135], v[88:91], v[52:55], v[132:135]
    s_waitcnt lgkmcnt(1)
    v_mfma_f32_16x16x32_bf16 v[128:131], v[92:95], v[56:59], v[128:131]
    v_mfma_f32_16x16x32_bf16 v[132:135], v[92:95], v[60:63], v[132:135]
    s_waitcnt lgkmcnt(0)
    v_mfma_f32_16x16x32_bf16 v[128:131], v[96:99], v[64:67], v[128:131]
    v_mfma_f32_16x16x32_bf16 v[132:135], v[96:99], v[68:71], v[132:135]
    v_and_b32 v6, 16, v1
    v_cmp_ne_u32 vcc, 0, v6
    s_nop 4
    v_cndmask_b32 v10, v128, v129, vcc
    v_cndmask_b32 v6, v132, v133, vcc
    v_cmp_lt_u32 vcc, 31, v1
    s_nop 1
    v_cndmask_b32 v10, v10, v6, vcc
    v_lshlrev_b32 v6, 3, v1
    v_add_u32 v7, 4, v6
    ds_bpermute_b32 v12, v6, v10
    ds_bpermute_b32 v14, v7, v10
    v_mov_b32 v13, s11
    v_mov_b32 v15, s11
    s_waitcnt lgkmcnt(0)
    s_mov_b32 exec_hi, 0
    buffer_store_dwordx4 v[12:15], v8, s[52:55], s14 offen
    s_add_u32 s13, s14, 131072
    buffer_store_dwordx4 v[12:15], v8, s[52:55], s13 offen sc1
    s_mov_b64 exec, -1
    v_lshlrev_b32 v4, 4, v1
    s_lshl_b32 s14, s6, 15
    s_lshl_b32 s13, s4, 12
    s_add_u32 s14, s14, s13
    s_add_u32 s14, s14, 262144
    v_lshlrev_b32 v5, 2, v1
    v_add_u32 v5, 161536, v5
    s_cmp_lt_u32 s10, 14
    s_cselect_b32 s62, 22, 26
    s_mov_b32 s15, 262136
    v_mov_b32 v6, 163464
Lw_7:
    ds_read_b32 v7, v6
    s_waitcnt lgkmcnt(0)
    v_readfirstlane_b32 s13, v7
    s_nop 0
    s_cmp_ge_u32 s13, s62
    s_nop 1
    s_cbranch_scc1 Lwd_8
    s_sleep 2
    s_sub_u32 s15, s15, 1
    s_cmp_lg_u32 s15, 0
    s_cbranch_scc1 Lw_7
Lwd_8:
    s_mov_b32 s15, 32767
    s_mov_b32 s63, s14
    s_add_u32 s12, s63, 0x10000
Lpoll_9:
    buffer_load_dwordx4 v[72:75], v4, s[52:55], s63 offen offset:0 sc1
    buffer_load_dwordx4 v[76:79], v4, s[52:55], s63 offen offset:1024 sc1
    buffer_load_dwordx4 v[80:83], v4, s[52:55], s63 offen offset:2048 sc1
    buffer_load_dwordx4 v[84:87], v4, s[52:55], s63 offen offset:3072 sc1
    buffer_load_dwordx4 v[88:91], v4, s[52:55], s12 offen offset:0 sc1
    buffer_load_dwordx4 v[92:95], v4, s[52:55], s12 offen offset:1024 sc1
    buffer_load_dwordx4 v[96:99], v4, s[52:55], s12 offen offset:2048 sc1
    buffer_load_dwordx4 v[100:103], v4, s[52:55], s12 offen offset:3072 sc1
    s_sub_u32 s15, s15, 1
    s_and_b32 s63, s15, 7
    s_cselect_b32 s63, 0, 131072
    s_add_u32 s63, s63, s14
    s_add_u32 s12, s63, 0x10000
    s_waitcnt vmcnt(0)
    v_xor_b32 v6, s11, v73
    v_bitop3_b32 v6, v6, v75, s11 bitop3:0xf6
    v_bitop3_b32 v6, v6, v77, s11 bitop3:0xf6
    v_bitop3_b32 v6, v6, v79, s11 bitop3:0xf6
    v_bitop3_b32 v6, v6, v81, s11 bitop3:0xf6
    v_bitop3_b32 v6, v6, v83, s11 bitop3:0xf6
    v_bitop3_b32 v6, v6, v85, s11 bitop3:0xf6
    v_bitop3_b32 v6, v6, v87, s11 bitop3:0xf6
    v_bitop3_b32 v6, v6, v89, s11 bitop3:0xf6
    v_bitop3_b32 v6, v6, v91, s11 bitop3:0xf6
    v_bitop3_b32 v6, v6, v93, s11 bitop3:0xf6
    v_bitop3_b32 v6, v6, v95, s11 bitop3:0xf6
    v_bitop3_b32 v6, v6, v97, s11 bitop3:0xf6
    v_bitop3_b32 v6, v6, v99, s11 bitop3:0xf6
    v_bitop3_b32 v6, v6, v101, s11 bitop3:0xf6
    v_bitop3_b32 v6, v6, v103, s11 bitop3:0xf6
    v_cmp_ne_u32 vcc, 0, v6
    s_nop 0
    s_cbranch_vccz Lpolld_10
    s_sleep 8
    s_cmp_lg_u32 s15, 0
    s_cbranch_scc1 Lpoll_9
Lpolld_10:
    v_add_f32 v6, v72, v88
    v_add_f32 v7, v74, v90
    v_cvt_pk_bf16_f32 v6, v6, v7
    ds_write_b32 v5, v6 offset:0
    v_add_f32 v6, v76, v92
    v_add_f32 v7, v78, v94
    v_cvt_pk_bf16_f32 v6, v6, v7
    ds_write_b32 v5, v6 offset:256
    v_add_f32 v6, v80, v96
    v_add_f32 v7, v82, v98
    v_cvt_pk_bf16_f32 v6, v6, v7
    ds_write_b32 v5, v6 offset:512
    v_add_f32 v6, v84, v100
    v_add_f32 v7, v86, v102
    v_cvt_pk_bf16_f32 v6, v6, v7
    ds_write_b32 v5, v6 offset:768
L_h1end:
    v_mov_b32 v5, 163456
    v_mov_b32 v6, 1
    v_mov_b32 v7, s11
    s_waitcnt lgkmcnt(0)
    ds_write_b64 v5, v[6:7]
    s_cmp_ge_u32 s10, 28
    s_cbranch_scc1 L_hpre
    v_lshlrev_b32 v4, 4, v1
    v_and_b32 v5, 31, v1
    v_lshlrev_b32 v5, 4, v5
    v_bfe_u32 v10, v1, 2, 1
    v_mul_u32_u24 v10, 928, v10
    v_and_b32 v8, 3, v1
    v_lshl_add_u32 v10, v8, 3, v10
    v_add_u32 v10, 145408, v10
    v_bfe_u32 v8, v1, 3, 2
    v_lshl_add_u32 v11, v8, 5, v10
    v_lshrrev_b32 v8, 3, v1
    v_lshl_add_u32 v10, v8, 5, v10
    s_mov_b32 s14, 14848
    s_mov_b32 s63, 18432
    s_mov_b32 s15, 262136
    v_mov_b32 v6, 163464
Lw_11:
    ds_read_b32 v7, v6
    s_waitcnt lgkmcnt(0)
    v_readfirstlane_b32 s13, v7
    s_nop 0
    s_cmp_ge_u32 s13, 32
    s_nop 1
    s_cbranch_scc1 Lwd_12
    s_sleep 2
    s_sub_u32 s15, s15, 1
    s_cmp_lg_u32 s15, 0
    s_cbranch_scc1 Lw_11
Lwd_12:
    s_mov_b32 s15, 32767
Lpoll_13:
    buffer_load_dwordx4 v[16:19], v4, s[52:55], s14 offen offset:0 sc1
    buffer_load_dwordx4 v[20:23], v4, s[52:55], s14 offen offset:1024 sc1
    buffer_load_dwordx4 v[24:27], v4, s[52:55], s14 offen offset:2048 sc1
    buffer_load_dwordx4 v[28:31], v5, s[52:55], s14 offen offset:3072 sc1
    buffer_load_dwordx4 v[32:35], v4, s[52:55], s63 offen offset:0 sc1
    buffer_load_dwordx4 v[36:39], v4, s[52:55], s63 offen offset:1024 sc1
    buffer_load_dwordx4 v[40:43], v4, s[52:55], s63 offen offset:2048 sc1
    buffer_load_dwordx4 v[44:47], v5, s[52:55], s63 offen offset:3072 sc1
    s_waitcnt vmcnt(0)
    v_xor_b32 v6, s11, v17
    v_bitop3_b32 v6, v6, v19, s11 bitop3:0xf6
    v_bitop3_b32 v6, v6, v21, s11 bitop3:0xf6
    v_bitop3_b32 v6, v6, v23, s11 bitop3:0xf6
    v_bitop3_b32 v6, v6, v25, s11 bitop3:0xf6
    v_bitop3_b32 v6, v6, v27, s11 bitop3:0xf6
    v_bitop3_b32 v6, v6, v29, s11 bitop3:0xf6
    v_bitop3_b32 v6, v6, v31, s11 bitop3:0xf6
    v_bitop3_b32 v6, v6, v33, s11 bitop3:0xf6
    v_bitop3_b32 v6, v6, v35, s11 bitop3:0xf6
    v_bitop3_b32 v6, v6, v37, s11 bitop3:0xf6
    v_bitop3_b32 v6, v6, v39, s11 bitop3:0xf6
    v_bitop3_b32 v6, v6, v41, s11 bitop3:0xf6
    v_bitop3_b32 v6, v6, v43, s11 bitop3:0xf6
    v_bitop3_b32 v6, v6, v45, s11 bitop3:0xf6
    v_bitop3_b32 v6, v6, v47, s11 bitop3:0xf6
    v_cmp_ne_u32 vcc, 0, v6
    s_nop 0
    s_cbranch_vccz Lpolld_14
    s_sleep 8
    s_sub_u32 s15, s15, 1
    s_cmp_lg_u32 s15, 0
    s_cbranch_scc1 Lpoll_13
Lpolld_14:
    v_lshlrev_b32 v6, 16, v32
    v_and_b32 v7, 0xffff0000, v32
    v_add_f32 v6, 1.0, v6
    v_add_f32 v7, 1.0, v7
    v_cvt_pk_bf16_f32 v32, v6, v7
    v_lshlrev_b32 v6, 16, v34
    v_and_b32 v7, 0xffff0000, v34
    v_add_f32 v6, 1.0, v6
    v_add_f32 v7, 1.0, v7
    v_cvt_pk_bf16_f32 v34, v6, v7
    v_lshlrev_b32 v6, 16, v36
    v_and_b32 v7, 0xffff0000, v36
    v_add_f32 v6, 1.0, v6
    v_add_f32 v7, 1.0, v7
    v_cvt_pk_bf16_f32 v36, v6, v7
    v_lshlrev_b32 v6, 16, v38
    v_and_b32 v7, 0xffff0000, v38
    v_add_f32 v6, 1.0, v6
    v_add_f32 v7, 1.0, v7
    v_cvt_pk_bf16_f32 v38, v6, v7
    v_lshlrev_b32 v6, 16, v40
    v_and_b32 v7, 0xffff0000, v40
    v_add_f32 v6, 1.0, v6
    v_add_f32 v7, 1.0, v7
    v_cvt_pk_bf16_f32 v40, v6, v7
    v_lshlrev_b32 v6, 16, v42
    v_and_b32 v7, 0xffff0000, v42
    v_add_f32 v6, 1.0, v6
    v_add_f32 v7, 1.0, v7
    v_cvt_pk_bf16_f32 v42, v6, v7
    v_lshlrev_b32 v6, 16, v44
    v_and_b32 v7, 0xffff0000, v44
    v_add_f32 v6, 1.0, v6
    v_add_f32 v7, 1.0, v7
    v_cvt_pk_bf16_f32 v44, v6, v7
    v_lshlrev_b32 v6, 16, v46
    v_and_b32 v7, 0xffff0000, v46
    v_add_f32 v6, 1.0, v6
    v_add_f32 v7, 1.0, v7
    v_cvt_pk_bf16_f32 v46, v6, v7
    v_mov_b32 v17, v18
    ds_write_b64 v10, v[16:17] offset:5568
    v_mov_b32 v21, v22
    ds_write_b64 v10, v[20:21] offset:5824
    v_mov_b32 v25, v26
    ds_write_b64 v10, v[24:25] offset:6080
    v_mov_b32 v29, v30
    ds_write_b64 v11, v[28:29] offset:6336
    v_mov_b32 v33, v34
    ds_write_b64 v10, v[32:33] offset:3712
    v_mov_b32 v37, v38
    ds_write_b64 v10, v[36:37] offset:3968
    v_mov_b32 v41, v42
    ds_write_b64 v10, v[40:41] offset:4224
    v_mov_b32 v45, v46
    ds_write_b64 v11, v[44:45] offset:4480
    s_waitcnt lgkmcnt(0)
    s_branch L_hbar2
L_hidle:
    buffer_load_dword v135, v2, s[52:55], 0 offen sc1
    v_and_b32 v4, 3, v1
    v_lshlrev_b32 v4, 4, v4
    v_add_u32 v4, 163456, v4
    v_mov_b32 v6, 0
    v_mov_b32 v7, 0
    v_mov_b32 v8, 0
    v_mov_b32 v9, 0
    ds_write_b128 v4, v[6:9]
    s_waitcnt lgkmcnt(0)
    s_barrier
    s_waitcnt vmcnt(0)
    v_readfirstlane_b32 s11, v135
    s_nop 0
    s_mul_i32 s11, s11, 1664525
    s_add_u32 s11, s11, 1013904223
    s_cmp_lg_u32 s3, 3
    s_cbranch_scc1 L_hpre
    s_mov_b32 s15, 262136
    v_mov_b32 v6, 163464
Lw_15:
    ds_read_b32 v7, v6
    s_waitcnt lgkmcnt(0)
    v_readfirstlane_b32 s13, v7
    s_nop 0
    s_cmp_ge_u32 s13, 2
    s_nop 1
    s_cbranch_scc1 Lwd_16
    s_sleep 1
    s_sub_u32 s15, s15, 1
    s_cmp_lg_u32 s15, 0
    s_cbranch_scc1 Lw_15
Lwd_16:
    s_memrealtime s[100:101]
    s_waitcnt lgkmcnt(0)
    s_sub_u32 s100, s100, 170
    s_lshr_b32 s13, s2, 3
    s_cmp_lg_u32 s13, 16
    s_cbranch_scc1 L_not0
    v_mov_b32 v6, s100
    v_mov_b32 v7, s11
    s_lshl_b32 s13, s4, 7
    s_add_u32 s13, s13, 28672
    s_mov_b64 exec, 1
    buffer_store_dwordx2 v[6:7], v2, s[52:55], s13 offen sc1
    s_mov_b64 exec, -1
L_not0:
    v_and_b32 v14, 7, v1
    v_lshlrev_b32 v14, 7, v14
    v_add_u32 v14, 28672, v14
    s_mov_b32 s15, 262136
    v_mov_b32 v6, 163464
Lw_17:
    ds_read_b32 v7, v6
    s_waitcnt lgkmcnt(0)
    v_readfirstlane_b32 s13, v7
    s_nop 0
    s_cmp_ge_u32 s13, 7
    s_nop 1
    s_cbranch_scc1 Lwd_18
    s_sleep 2
    s_sub_u32 s15, s15, 1
    s_cmp_lg_u32 s15, 0
    s_cbranch_scc1 Lw_17
Lwd_18:
    buffer_load_dwordx2 v[8:9], v14, s[52:55], 0 offen sc1
    s_waitcnt vmcnt(0)
    s_memrealtime s[64:65]
    s_waitcnt lgkmcnt(0)
    v_mov_b32 v10, s100
    v_cmp_eq_u32 vcc, s11, v9
    s_nop 1
    v_cndmask_b32 v8, v10, v8, vcc
    v_sub_u32 v14, s64, v8
    s_nop 1
    v_max_u32_dpp v14, v14, v14 quad_perm:[1,0,3,2] row_mask:0xf bank_mask:0xf
    s_nop 1
    v_max_u32_dpp v14, v14, v14 quad_perm:[2,3,0,1] row_mask:0xf bank_mask:0xf
    s_nop 1
    v_max_u32_dpp v14, v14, v14 row_half_mirror row_mask:0xf bank_mask:0xf
    s_cmp_ge_u32 s10, 56
    s_cselect_b32 s13, 0, 0
    s_cmp_eq_u32 s10, 40
    s_cselect_b32 s13, 50, s13
    s_sub_u32 s64, s64, s13
    v_sub_u32 v14, s64, v14
    v_or_b32 v14, 1, v14
    v_mov_b32 v15, 163516
    ds_write_b32 v15, v14
L_hpre:
    s_cmp_lt_u32 s10, 28
    s_cbranch_scc1 L_hstat
    s_cmp_ge_u32 s10, 56
    s_cbranch_scc1 L_hstat
L_pre_wo:
    s_mov_b32 s61, s4
    s_sub_u32 s62, s5, 18
    s_lshl_b32 s12, s61, 2
    s_add_u32 s63, s12, s3
    s_mul_i32 s60, s3, 6144
    s_add_u32 s60, s60, 131072
    s_mov_b32 s48, s24
    s_mov_b32 s49, s25
    s_mov_b32 s50, 3670016
    s_mov_b32 s51, 0x20000
    s_mul_i32 s46, s63, 114688
    s_lshl_b32 s13, s62, 6
    s_add_u32 s46, s46, s13
    s_cmp_lg_u32 s3, 2
    s_cbranch_scc1 L_nowarm
    s_cmp_ge_u32 s62, 2
    s_cbranch_scc1 L_nowarm
    v_bfe_u32 v8, v1, 4, 1
    v_lshlrev_b32 v8, 14, v8
    v_and_b32 v9, 15, v1
    v_lshl_add_u32 v8, v9, 7, v8
    s_lshl_b32 s12, s4, 11
    s_add_u32 s12, s12, 65536
    s_mov_b32 s15, 262136
    v_mov_b32 v6, 163464
Lw_19:
    ds_read_b32 v7, v6
    s_waitcnt lgkmcnt(0)
    v_readfirstlane_b32 s13, v7
    s_nop 0
    s_cmp_ge_u32 s13, 20
    s_nop 1
    s_cbranch_scc1 Lwd_20
    s_sleep 2
    s_sub_u32 s15, s15, 1
    s_cmp_lg_u32 s15, 0
    s_cbranch_scc1 Lw_19
Lwd_20:
    buffer_load_dword v10, v8, s[52:55], s12 offen sc1
L_nowarm:
    v_lshrrev_b32 v4, 2, v1
    v_mul_u32_u24 v4, 896, v4
    v_lshrrev_b32 v6, 3, v1
    v_and_b32 v6, 2, v6
    v_xor_b32 v6, v6, v1
    v_and_b32 v6, 3, v6
    v_lshl_add_u32 v4, v6, 4, v4
    v_lshrrev_b32 v8, 2, v1
    v_lshlrev_b32 v8, 6, v8
    v_and_b32 v6, 3, v1
    v_lshl_add_u32 v8, v6, 3, v8
    v_and_b32 v6, 16, v1
    v_lshl_add_u32 v8, v6, 1, v8
    v_add_u32 v8, s60, v8
    v_xor_b32 v9, 32, v8
    s_mov_b32 s15, 262136
    v_mov_b32 v6, 163456
Lw_21:
    ds_read_b32 v7, v6
    s_waitcnt lgkmcnt(0)
    v_readfirstlane_b32 s13, v7
    s_nop 0
    s_cmp_ge_u32 s13, 1
    s_nop 1
    s_cbranch_scc1 Lwd_22
    s_sleep 2
    s_sub_u32 s15, s15, 1
    s_cmp_lg_u32 s15, 0
    s_cbranch_scc1 Lw_21
Lwd_22:
    s_mov_b32 s15, 262136
    v_mov_b32 v6, 163464
Lw_23:
    ds_read_b32 v7, v6
    s_waitcnt lgkmcnt(0)
    v_readfirstlane_b32 s13, v7
    s_nop 0
    s_cmp_ge_u32 s13, 30
    s_nop 1
    s_cbranch_scc1 Lwd_24
    s_sleep 2
    s_sub_u32 s15, s15, 1
    s_cmp_lg_u32 s15, 0
    s_cbranch_scc1 Lw_23
Lwd_24:
    s_add_u32 s13, s46, 0
    s_add_u32 m0, s60, 0
    s_nop 0
    buffer_load_dwordx4 v4, s[48:51], s13 offen nt lds
    s_add_u32 s13, s46, 14336
    s_add_u32 m0, s60, 1024
    s_nop 0
    buffer_load_dwordx4 v4, s[48:51], s13 offen nt lds
    s_waitcnt vmcnt(0)
    ds_read_b64_tr_b16 v[16:17], v8 offset:0
    ds_read_b64_tr_b16 v[18:19], v8 offset:1024
    ds_read_b64_tr_b16 v[20:21], v9 offset:0
    ds_read_b64_tr_b16 v[22:23], v9 offset:1024
    s_waitcnt lgkmcnt(0)
    s_cmp_lg_u32 s3, 1
    s_cbranch_scc1 L_wo_n1
    s_mov_b32 s64, s16
    s_mov_b32 s65, s17
    s_mov_b32 s66, 1792
    s_mov_b32 s67, 0x20000
    v_bfe_u32 v8, v1, 4, 1
    v_and_b32 v9, 15, v1
    v_mul_u32_u24 v10, 896, v8
    v_lshl_add_u32 v10, v9, 2, v10
    s_lshl_b32 s12, s62, 6
    v_lshlrev_b32 v11, 6, v8
    v_and_b32 v8, 7, v1
    v_lshl_add_u32 v11, v8, 3, v11
    v_bfe_u32 v8, v1, 3, 1
    v_lshl_add_u32 v11, v8, 7, v11
    s_lshl_b32 s14, s62, 8
    s_add_u32 s47, s14, 18432
    s_add_u32 s14, s14, 11264
    s_mov_b32 s15, 262136
    v_mov_b32 v6, 163464
Lw_25:
    ds_read_b32 v7, v6
    s_waitcnt lgkmcnt(0)
    v_readfirstlane_b32 s13, v7
    s_nop 0
    s_cmp_ge_u32 s13, 32
    s_nop 1
    s_cbranch_scc1 Lwd_26
    s_sleep 2
    s_sub_u32 s15, s15, 1
    s_cmp_lg_u32 s15, 0
    s_cbranch_scc1 Lw_25
Lwd_26:
    buffer_load_dword v52, v10, s[64:67], s12 offen
    s_mov_b32 s15, 32767
Lpoll_27:
    buffer_load_dwordx2 v[48:49], v11, s[52:55], s14 offen sc1
    buffer_load_dwordx2 v[50:51], v11, s[52:55], s47 offen sc1
    s_waitcnt vmcnt(0)
    v_xor_b32 v6, s11, v49
    v_bitop3_b32 v6, v6, v51, s11 bitop3:0xf6
    v_cmp_ne_u32 vcc, 0, v6
    s_nop 0
    s_cbranch_vccz Lpolld_28
    s_sleep 8
    s_sub_u32 s15, s15, 1
    s_cmp_lg_u32 s15, 0
    s_cbranch_scc1 Lpoll_27
Lpolld_28:
    v_lshlrev_b32 v56, 16, v52
    v_and_b32 v57, 0xffff0000, v52
    v_lshlrev_b32 v58, 16, v48
    v_and_b32 v59, 0xffff0000, v48
    v_lshlrev_b32 v60, 16, v50
    v_and_b32 v61, 0xffff0000, v50
    v_add_f32 v60, 1.0, v60
    v_add_f32 v61, 1.0, v61
    v_cvt_pk_bf16_f32 v6, v60, v61
    v_lshlrev_b32 v60, 16, v6
    v_and_b32 v61, 0xffff0000, v6
    s_nop 0
    s_branch L_hbar2
L_wo_n1:
    s_cmp_lg_u32 s3, 2
    s_cbranch_scc1 L_hstat
    s_sub_u32 s14, s46, 229376
    s_mov_b32 s12, 155648
    s_add_u32 s13, s14, 0
    s_add_u32 m0, s12, 0
    s_nop 0
    buffer_load_dwordx4 v4, s[48:51], s13 offen nt lds
    s_add_u32 s13, s14, 14336
    s_add_u32 m0, s12, 1024
    s_nop 0
    buffer_load_dwordx4 v4, s[48:51], s13 offen nt lds
    s_waitcnt vmcnt(0)
L_hstat:
    s_cmp_lg_u32 s3, 3
    s_cbranch_scc1 L_hbar2
    v_bfe_u32 v8, v1, 4, 1
    v_lshlrev_b32 v9, 5, v8
    v_add_u32 v9, 163328, v9
    s_lshl_b32 s14, s4, 11
    s_add_u32 s14, s14, 32768
    s_lshl_b32 s12, s7, 7
    s_add_u32 s12, s12, s14
    s_lshl_b32 s13, s6, 14
    s_add_u32 s12, s12, s13
    v_cmp_lt_u32 s[44:45], 31, v1
    v_lshlrev_b32 v10, 4, v8
    s_nop 0
    v_cndmask_b32 v10, v10, 32, s[44:45]
    v_mov_b32 v6, s13
    v_lshlrev_b32 v7, 14, v8
    v_cndmask_b32 v6, v6, v7, s[44:45]
    v_and_b32 v11, 15, v1
    v_lshl_add_u32 v11, v11, 7, v10
    v_add_u32 v11, v11, v6
    s_getreg_b32 s42, hwreg(HW_REG_XCC_ID)
    s_and_b32 s42, s42, 15
    s_mov_b32 s15, 262136
    v_mov_b32 v6, 163508
Lw_29:
    ds_read_b32 v7, v6
    s_waitcnt lgkmcnt(0)
    v_readfirstlane_b32 s13, v7
    s_nop 0
    s_cmp_ge_u32 s13, 8
    s_nop 1
    s_cbranch_scc1 Lwd_30
    s_sleep 2
    s_sub_u32 s15, s15, 1
    s_cmp_lg_u32 s15, 0
    s_cbranch_scc1 Lw_29
Lwd_30:
    ds_read_b128 v[128:131], v9
    ds_read_b128 v[132:135], v9 offset:16
    ds_read_b128 v[136:139], v9 offset:64
    ds_read_b128 v[140:143], v9 offset:80
    s_waitcnt lgkmcnt(0)
    v_max3_f32 v12, v128, v129, v130
    v_max3_f32 v12, v12, v131, v132
    v_max3_f32 v12, v12, v133, v134
    v_max_f32 v12, v12, v135
    v_add_f32 v14, v136, v137
    v_add_f32 v14, v14, v138
    v_add_f32 v14, v14, v139
    v_add_f32 v14, v14, v140
    v_add_f32 v14, v14, v141
    v_add_f32 v14, v14, v142
    v_add_f32 v14, v14, v143
    v_mov_b32 v13, s11
    v_mov_b32 v15, s11
    v_mov_b32 v6, s42
    v_cndmask_b32 v12, v12, v6, s[44:45]
    s_mov_b32 exec_lo, 0x10001
    s_mov_b32 exec_hi, 1
    buffer_store_dwordx4 v[12:15], v10, s[52:55], s12 offen
    s_add_u32 s13, s12, 163840
    buffer_store_dwordx4 v[12:15], v10, s[52:55], s13 offen sc1
    s_mov_b64 exec, -1
    s_mov_b32 s15, 262136
    v_mov_b32 v6, 163464
Lw_31:
    ds_read_b32 v7, v6
    s_waitcnt lgkmcnt(0)
    v_readfirstlane_b32 s13, v7
    s_nop 0
    s_cmp_ge_u32 s13, 44
    s_nop 1
    s_cbranch_scc1 Lwd_32
    s_sleep 2
    s_sub_u32 s15, s15, 1
    s_cmp_lg_u32 s15, 0
    s_cbranch_scc1 Lw_31
Lwd_32:
    s_mov_b32 s15, 32767
    s_mov_b32 s12, s14
Lpoll_33:
    buffer_load_dwordx4 v[128:131], v11, s[52:55], s12 offen sc1
    s_sub_u32 s15, s15, 1
    s_and_b32 s12, s15, 7
    s_cselect_b32 s12, 0, 163840
    s_add_u32 s12, s12, s14
    s_waitcnt vmcnt(0)
    v_xor_b32 v6, s11, v129
    v_bitop3_b32 v6, v6, v131, s11 bitop3:0xf6
    v_cmp_ne_u32 vcc, 0, v6
    s_nop 0
    s_cbranch_vccz Lpolld_34
    s_sleep 8
    s_cmp_lg_u32 s15, 0
    s_cbranch_scc1 Lpoll_33
Lpolld_34:
    s_waitcnt vmcnt(0)
    v_mov_b32 v6, v128
    s_nop 1
    v_max_f32_dpp v6, v6, v6 quad_perm:[1,0,3,2] row_mask:0xf bank_mask:0xf
    s_nop 1
    v_max_f32_dpp v6, v6, v6 quad_perm:[2,3,0,1] row_mask:0xf bank_mask:0xf
    s_nop 1
    v_max_f32_dpp v6, v6, v6 row_half_mirror row_mask:0xf bank_mask:0xf
    s_nop 1
    v_max_f32_dpp v6, v6, v6 row_mirror row_mask:0xf bank_mask:0xf
    v_sub_f32 v7, v128, v6
    v_mul_f32 v7, 0x3db8aa3b, v7
    v_exp_f32 v7, v7
    s_nop 0
    v_mul_f32 v7, v7, v130
    s_nop 1
    v_add_f32_dpp v7, v7, v7 quad_perm:[1,0,3,2] row_mask:0xf bank_mask:0xf
    s_nop 1
    v_add_f32_dpp v7, v7, v7 quad_perm:[2,3,0,1] row_mask:0xf bank_mask:0xf
    s_nop 1
    v_add_f32_dpp v7, v7, v7 row_half_mirror row_mask:0xf bank_mask:0xf
    s_nop 1
    v_add_f32_dpp v7, v7, v7 row_mirror row_mask:0xf bank_mask:0xf
    v_sub_f32 v6, v12, v6
    v_mul_f32 v6, 0x3db8aa3b, v6
    v_exp_f32 v6, v6
    v_rcp_f32 v7, v7
    s_nop 0
    v_mul_f32 v6, v6, v7
    v_lshlrev_b32 v9, 2, v8
    v_add_u32 v9, 163520, v9
    v_cmp_eq_u32 vcc, s42, v128
    v_mov_b32 v10, 163528
    s_cmp_eq_u32 vcc_hi, -1
    s_cselect_b32 s13, 1, 0
    v_mov_b32 v7, s13
    s_mov_b32 exec_hi, 0
    ds_write_b32 v9, v6
    ds_write_b32 v10, v7
    s_mov_b64 exec, -1
    s_waitcnt lgkmcnt(0)
L_hbar2:
    s_cmp_lg_u32 s10, 40
    s_cbranch_scc1 L_hbar2b
    s_mov_b32 s61, s4
    s_sub_u32 s62, s5, 18
    s_lshl_b32 s12, s61, 2
    s_add_u32 s63, s12, s3
    s_mul_i32 s60, s3, 6144
    s_add_u32 s60, s60, 131072
    s_mov_b32 s48, s24
    s_mov_b32 s49, s25
    s_mov_b32 s50, 3670016
    s_mov_b32 s51, 0x20000
    s_mul_i32 s46, s63, 114688
    s_lshl_b32 s13, s62, 6
    s_add_u32 s46, s46, s13
    v_lshrrev_b32 v4, 2, v1
    v_mul_u32_u24 v4, 896, v4
    v_lshrrev_b32 v6, 3, v1
    v_and_b32 v6, 2, v6
    v_xor_b32 v6, v6, v1
    v_and_b32 v6, 3, v6
    v_lshl_add_u32 v4, v6, 4, v4
    s_mov_b32 s15, 262136
    v_mov_b32 v6, 163464
Lw_35:
    ds_read_b32 v7, v6
    s_waitcnt lgkmcnt(0)
    v_readfirstlane_b32 s13, v7
    s_nop 0
    s_cmp_ge_u32 s13, 63
    s_nop 1
    s_cbranch_scc1 Lwd_36
    s_sleep 2
    s_sub_u32 s15, s15, 1
    s_cmp_lg_u32 s15, 0
    s_cbranch_scc1 Lw_35
Lwd_36:
    s_add_u32 s13, s46, 28672
    s_add_u32 m0, s60, 0
    s_nop 0
    buffer_load_dwordx4 v4, s[48:51], s13 offen nt lds
    s_add_u32 s13, s46, 43008
    s_add_u32 m0, s60, 1024
    s_nop 0
    buffer_load_dwordx4 v4, s[48:51], s13 offen nt lds
    s_add_u32 s13, s46, 57344
    s_add_u32 m0, s60, 2048
    s_nop 0
    buffer_load_dwordx4 v4, s[48:51], s13 offen nt lds
    s_add_u32 s13, s46, 71680
    s_add_u32 m0, s60, 3072
    s_nop 0
    buffer_load_dwordx4 v4, s[48:51], s13 offen nt lds
    s_add_u32 s13, s46, 86016
    s_add_u32 m0, s60, 4096
    s_nop 0
    buffer_load_dwordx4 v4, s[48:51], s13 offen nt lds
    s_add_u32 s13, s46, 100352
    s_add_u32 m0, s60, 5120
    s_nop 0
    buffer_load_dwordx4 v4, s[48:51], s13 offen nt lds
L_hbar2b:
    s_barrier
    s_barrier
    s_cmp_lt_u32 s10, 28
    s_cbranch_scc1 L_post_gu
    s_cmp_ge_u32 s10, 63
    s_cbranch_scc1 L_hend
    s_cmp_ge_u32 s10, 56
    s_cbranch_scc1 L_post_dn
    s_cmp_lg_u32 s3, 0
    s_cbranch_scc1 L_post_wo
    s_mov_b32 s12, 155648
    v_lshrrev_b32 v8, 2, v1
    v_lshlrev_b32 v8, 6, v8
    v_and_b32 v6, 3, v1
    v_lshl_add_u32 v8, v6, 3, v8
    v_and_b32 v6, 16, v1
    v_lshl_add_u32 v8, v6, 1, v8
    v_add_u32 v8, s12, v8
    v_xor_b32 v9, 32, v8
    ds_read_b64_tr_b16 v[16:17], v8 offset:0
    ds_read_b64_tr_b16 v[18:19], v8 offset:1024
    ds_read_b64_tr_b16 v[20:21], v9 offset:0
    ds_read_b64_tr_b16 v[22:23], v9 offset:1024
L_post_wo:
    v_lshrrev_b32 v8, 2, v1
    v_lshlrev_b32 v8, 6, v8
    v_and_b32 v6, 3, v1
    v_lshl_add_u32 v8, v6, 3, v8
    v_and_b32 v6, 16, v1
    v_lshl_add_u32 v8, v6, 1, v8
    v_add_u32 v8, s60, v8
    v_xor_b32 v9, 32, v8
    s_waitcnt vmcnt(0)
    ds_read_b64_tr_b16 v[24:25], v8 offset:0
    ds_read_b64_tr_b16 v[26:27], v8 offset:1024
    ds_read_b64_tr_b16 v[28:29], v9 offset:0
    ds_read_b64_tr_b16 v[30:31], v9 offset:1024
    ds_read_b64_tr_b16 v[32:33], v8 offset:2048
    ds_read_b64_tr_b16 v[34:35], v8 offset:3072
    ds_read_b64_tr_b16 v[36:37], v9 offset:2048
    ds_read_b64_tr_b16 v[38:39], v9 offset:3072
    ds_read_b64_tr_b16 v[40:41], v8 offset:4096
    ds_read_b64_tr_b16 v[42:43], v8 offset:5120
    ds_read_b64_tr_b16 v[44:45], v9 offset:4096
    ds_read_b64_tr_b16 v[46:47], v9 offset:5120
    s_lshl_b32 s14, s63, 9
    s_add_u32 s14, s14, 65536
    v_lshrrev_b32 v5, 5, v1
    v_and_b32 v6, 31, v1
    v_lshlrev_b32 v4, 14, v5
    v_lshl_add_u32 v4, v6, 4, v4
    v_lshlrev_b32 v8, 3, v1
    v_add_u32 v8, s60, v8
    v_and_b32 v7, 1, v1
    v_mul_u32_u24 v7, 256, v7
    v_lshrrev_b32 v6, 4, v1
    v_lshl_add_u32 v7, v6, 3, v7
    v_add_u32 v7, s60, v7
    v_lshlrev_b32 v9, 3, v1
    s_lshl_b32 s12, s3, 8
    s_add_u32 s12, s12, 159744
    v_add_u32 v9, s12, v9
    v_bfe_u32 v3, v1, 3, 1
    v_mul_u32_u24 v3, 3584, v3
    v_and_b32 v5, 7, v1
    v_lshl_add_u32 v3, v5, 4, v3
    v_bfe_u32 v5, v1, 4, 1
    v_lshl_add_u32 v3, v5, 7, v3
    v_and_b32 v5, 7, v1
    v_lshlrev_b32 v5, 4, v5
    v_bfe_u32 v6, v1, 3, 1
    v_lshl_add_u32 v5, v6, 2, v5
    v_bfe_u32 v6, v1, 4, 1
    v_lshl_add_u32 v5, v6, 7, v5
    v_add_u32 v5, 159744, v5
    s_waitcnt lgkmcnt(0)
    s_mov_b32 s58, s62
    s_mul_i32 s13, s61, 7168
    s_lshl_b32 s62, s62, 8
    s_add_u32 s62, s62, s13
    s_add_u32 s62, s62, 131072
    v_mov_b32 v13, s11
    v_mov_b32 v15, s11
    s_mov_b32 s15, 32767
Lpoll_37:
    buffer_load_dwordx4 v[128:131], v4, s[52:55], s14 offen sc1
    s_waitcnt vmcnt(0)
    v_xor_b32 v6, s11, v129
    v_bitop3_b32 v6, v6, v131, s11 bitop3:0xf6
    v_cmp_ne_u32 vcc, 0, v6
    s_nop 0
    s_cbranch_vccz Lpolld_38
    s_sub_u32 s15, s15, 1
    s_cmp_lg_u32 s15, 0
    s_cbranch_scc1 Lpoll_37
Lpolld_38:
    v_mov_b32 v129, v130
    ds_write_b64 v8, v[128:129]
    ds_read2_b64 v[72:75], v7 offset0:0 offset1:4
    ds_read2_b64 v[76:79], v7 offset0:8 offset1:12
    ds_read2_b64 v[80:83], v7 offset0:16 offset1:20
    ds_read2_b64 v[84:87], v7 offset0:24 offset1:28
    s_waitcnt lgkmcnt(3)
    v_mfma_f32_16x16x32_bf16 v[136:139], v[72:75], v[16:19], 0
    v_mfma_f32_16x16x32_bf16 v[140:143], v[72:75], v[20:23], 0
    s_waitcnt lgkmcnt(2)
    v_mfma_f32_16x16x32_bf16 v[136:139], v[76:79], v[24:27], v[136:139]
    v_mfma_f32_16x16x32_bf16 v[140:143], v[76:79], v[28:31], v[140:143]
    s_waitcnt lgkmcnt(1)
    v_mfma_f32_16x16x32_bf16 v[136:139], v[80:83], v[32:35], v[136:139]
    v_mfma_f32_16x16x32_bf16 v[140:143], v[80:83], v[36:39], v[140:143]
    s_waitcnt lgkmcnt(0)
    v_mfma_f32_16x16x32_bf16 v[136:139], v[84:87], v[40:43], v[136:139]
    v_mfma_f32_16x16x32_bf16 v[140:143], v[84:87], v[44:47], v[140:143]
    s_mov_b32 exec_lo, 0xffff
    s_mov_b32 exec_hi, 0
    s_nop 4
    ds_write_b64 v9, v[136:137]
    ds_write_b64 v9, v[140:141] offset:128
    s_mov_b64 exec, -1
    s_waitcnt lgkmcnt(0)
    s_barrier
    s_cmp_eq_u32 s3, 1
    s_cbranch_scc1 L_colred
    s_cmp_lg_u32 s3, 0
    s_cbranch_scc1 L_hend
    ds_read2_b32 v[72:73], v5 offset0:0 offset1:2
    ds_read2_b32 v[74:75], v5 offset0:64 offset1:66
    ds_read2_b32 v[76:77], v5 offset0:128 offset1:130
    ds_read2_b32 v[78:79], v5 offset0:192 offset1:194
    s_waitcnt lgkmcnt(0)
    v_add_f32 v12, v72, v74
    v_add_f32 v14, v73, v75
    v_add_f32 v10, v76, v78
    v_add_f32 v11, v77, v79
    v_add_f32 v12, v12, v10
    v_add_f32 v14, v14, v11
    s_mov_b32 exec_hi, 0
    buffer_store_dwordx4 v[12:15], v3, s[52:55], s62 offen sc1
    s_mov_b64 exec, -1
    s_branch L_hend
L_colred:
    v_lshrrev_b32 v4, 5, v1
    v_mul_u32_u24 v4, 7168, v4
    v_bfe_u32 v5, v1, 4, 1
    v_mul_u32_u24 v5, 3584, v5
    v_add_u32 v4, v4, v5
    v_and_b32 v5, 15, v1
    v_lshl_add_u32 v4, v5, 4, v4
    s_lshl_b32 s44, s58, 8
    s_add_u32 s44, s44, 131072
    s_add_u32 s45, s44, 14336
    s_add_u32 s46, s44, 28672
    s_add_u32 s47, s44, 43008
    s_mul_i32 s12, s4, 14
    s_add_u32 s12, s12, s58
    s_lshl_b32 s12, s12, 10
    s_add_u32 s12, s12, 557056
    v_lshlrev_b32 v3, 4, v1
    v_mov_b32 v13, s11
    v_mov_b32 v15, s11
    v_mov_b32 v65, s11
    v_mov_b32 v67, s11
    v_lshlrev_b32 v5, 3, v1
    v_add_u32 v5, 512, v5
    v_and_b32 v6, 16, v1
    v_add_u32 v6, 768, v6
    v_cmp_lt_u32 vcc, 31, v1
    s_nop 1
    v_cndmask_b32 v5, v5, v6, vcc
    s_mov_b64 s[48:49], vcc
    v_mov_b32 v6, 163528
    ds_read_b32 v7, v6
    s_waitcnt lgkmcnt(0)
    v_readfirstlane_b32 s42, v7
    s_sleep 14
    s_mov_b32 s15, 32767
Lpoll_39:
    buffer_load_dwordx4 v[128:131], v4, s[52:55], s44 offen sc1
    buffer_load_dwordx4 v[132:135], v4, s[52:55], s45 offen sc1
    buffer_load_dwordx4 v[136:139], v4, s[52:55], s46 offen sc1
    buffer_load_dwordx4 v[140:143], v4, s[52:55], s47 offen sc1
    s_waitcnt vmcnt(0)
    v_xor_b32 v7, s11, v129
    v_bitop3_b32 v7, v7, v131, s11 bitop3:0xf6
    v_bitop3_b32 v7, v7, v133, s11 bitop3:0xf6
    v_bitop3_b32 v7, v7, v135, s11 bitop3:0xf6
    v_bitop3_b32 v7, v7, v137, s11 bitop3:0xf6
    v_bitop3_b32 v7, v7, v139, s11 bitop3:0xf6
    v_bitop3_b32 v7, v7, v141, s11 bitop3:0xf6
    v_bitop3_b32 v7, v7, v143, s11 bitop3:0xf6
    v_cmp_ne_u32 vcc, 0, v7
    s_nop 0
    s_cbranch_vccz Lpolld_40
    s_sub_u32 s15, s15, 1
    s_cmp_lg_u32 s15, 0
    s_cbranch_scc1 Lpoll_39
Lpolld_40:
    v_add_f32 v8, v128, v132
    v_add_f32 v9, v130, v134
    v_add_f32 v10, v136, v140
    v_add_f32 v11, v138, v142
    v_add_f32 v8, v8, v10
    v_add_f32 v9, v9, v11
    v_mov_b32 v10, v8
    v_mov_b32 v11, v9
    s_nop 0
    v_permlane32_swap_b32 v8, v10
    v_permlane32_swap_b32 v9, v11
    v_add_f32 v8, v8, v10
    v_add_f32 v9, v9, v11
    v_cvt_pk_bf16_f32 v7, v8, v9
    v_lshlrev_b32 v8, 16, v7
    v_and_b32 v9, 0xffff0000, v7
    v_mul_f32 v8, v8, v58
    v_mul_f32 v9, v9, v59
    v_cvt_pk_bf16_f32 v7, v8, v9
    v_lshlrev_b32 v8, 16, v7
    v_and_b32 v9, 0xffff0000, v7
    v_add_f32 v8, v8, v56
    v_add_f32 v9, v9, v57
    v_cvt_pk_bf16_f32 v64, v8, v9
    v_lshlrev_b32 v8, 16, v64
    v_and_b32 v9, 0xffff0000, v64
    v_mul_f32 v10, v8, v60
    v_mul_f32 v11, v9, v61
    v_cvt_pk_bf16_f32 v12, v10, v11
    v_lshlrev_b32 v6, 16, v12
    v_and_b32 v7, 0xffff0000, v12
    v_sub_f32 v10, v10, v6
    v_sub_f32 v11, v11, v7
    v_cvt_pk_bf16_f32 v14, v10, v11
    s_mov_b32 exec_hi, 0
    s_cmp_lg_u32 s42, 1
    s_cbranch_scc1 Lsg_41
    buffer_store_dwordx4 v[12:15], v3, s[52:55], s12 offen
Lsd_42:
    s_mov_b64 exec, -1
    v_mov_b32_dpp v68, v8 row_newbcast:0 row_mask:0xf bank_mask:0xf
    v_mov_b32_dpp v66, v64 quad_perm:[1,0,3,2] row_mask:0xf bank_mask:0xf
    v_sub_f32 v62, v8, v68
    v_sub_f32 v63, v9, v68
    v_add_f32 v70, v62, v63
    v_mul_f32 v71, v62, v62
    v_fmac_f32 v71, v63, v63
    v_add_f32_dpp v70, v70, v70 quad_perm:[1,0,3,2] row_mask:0xf bank_mask:0xf
    s_nop 0
    v_add_f32_dpp v71, v71, v71 quad_perm:[1,0,3,2] row_mask:0xf bank_mask:0xf
    v_add_f32_dpp v70, v70, v70 quad_perm:[2,3,0,1] row_mask:0xf bank_mask:0xf
    s_nop 0
    v_add_f32_dpp v71, v71, v71 quad_perm:[2,3,0,1] row_mask:0xf bank_mask:0xf
    v_add_f32_dpp v70, v70, v70 row_half_mirror row_mask:0xf bank_mask:0xf
    s_nop 0
    v_add_f32_dpp v71, v71, v71 row_half_mirror row_mask:0xf bank_mask:0xf
    v_add_f32_dpp v70, v70, v70 row_mirror row_mask:0xf bank_mask:0xf
    s_nop 0
    v_add_f32_dpp v71, v71, v71 row_mirror row_mask:0xf bank_mask:0xf
    v_mul_f32 v62, 0x3d000000, v70
    v_fma_f32 v71, -v62, v70, v71
    v_add_f32 v62, v62, v68
    v_cndmask_b32 v64, v64, v62, s[48:49]
    v_cndmask_b32 v66, v66, v71, s[48:49]
    s_mov_b32 exec_lo, 0
    s_mov_b32 exec_hi, 0x10001
    s_cmp_lg_u32 s42, 1
    s_cbranch_scc1 Lsg_43
    buffer_store_dwordx4 v[64:67], v5, s[52:55], s12 offen
Lsd_44:
    s_mov_b32 exec_lo, 0x55555555
    s_mov_b32 exec_hi, 0
    s_cmp_lg_u32 s42, 1
    s_cbranch_scc1 Lsg_45
    buffer_store_dwordx4 v[64:67], v5, s[52:55], s12 offen
Lsd_46:
    s_mov_b64 exec, -1
    s_branch L_hend
L_post_gu:
    s_cmp_lt_u32 s9, 2
    s_cselect_b32 s56, s28, s30
    s_cselect_b32 s57, s29, s31
    s_mov_b32 s58, 1605632
    s_mov_b32 s59, 0x20000
    s_lshl_b32 s62, s10, 1
    s_and_b32 s13, s9, 1
    s_add_u32 s62, s62, s13
    s_mul_i32 s14, s3, 401408
    s_lshl_b32 s13, s62, 6
    s_add_u32 s14, s14, s13
    s_mul_i32 s60, s3, 7168
    v_lshrrev_b32 v4, 2, v1
    v_mul_u32_u24 v4, 3584, v4
    v_lshrrev_b32 v6, 3, v1
    v_and_b32 v6, 2, v6
    v_xor_b32 v6, v6, v1
    v_and_b32 v6, 3, v6
    v_lshl_add_u32 v4, v6, 4, v4
    s_add_u32 s13, s14, 0
    s_add_u32 m0, s60, 0
    s_nop 0
    buffer_load_dwordx4 v4, s[56:59], s13 offen nt lds
    s_add_u32 s13, s14, 57344
    s_add_u32 m0, s60, 1024
    s_nop 0
    buffer_load_dwordx4 v4, s[56:59], s13 offen nt lds
    s_add_u32 s13, s14, 114688
    s_add_u32 m0, s60, 2048
    s_nop 0
    buffer_load_dwordx4 v4, s[56:59], s13 offen nt lds
    s_add_u32 s13, s14, 172032
    s_add_u32 m0, s60, 3072
    s_nop 0
    buffer_load_dwordx4 v4, s[56:59], s13 offen nt lds
    s_add_u32 s13, s14, 229376
    s_add_u32 m0, s60, 4096
    s_nop 0
    buffer_load_dwordx4 v4, s[56:59], s13 offen nt lds
    s_add_u32 s13, s14, 286720
    s_add_u32 m0, s60, 5120
    s_nop 0
    buffer_load_dwordx4 v4, s[56:59], s13 offen nt lds
    s_add_u32 s13, s14, 344064
    s_add_u32 m0, s60, 6144
    s_nop 0
    buffer_load_dwordx4 v4, s[56:59], s13 offen nt lds
    s_and_b32 s12, s3, 1
    s_mul_i32 s60, s12, 14336
    v_lshrrev_b32 v8, 2, v1
    v_lshlrev_b32 v8, 6, v8
    v_and_b32 v6, 3, v1
    v_lshl_add_u32 v8, v6, 3, v8
    v_and_b32 v6, 16, v1
    v_lshl_add_u32 v8, v6, 1, v8
    v_add_u32 v8, s60, v8
    v_xor_b32 v9, 32, v8
    s_lshr_b32 s13, s3, 1
    s_lshl_b32 s13, s13, 5
    v_xor_b32 v8, s13, v8
    v_and_b32 v7, 7, v1
    v_mul_u32_u24 v7, 928, v7
    v_lshrrev_b32 v6, 4, v1
    v_lshl_add_u32 v7, v6, 3, v7
    s_mul_i32 s12, s12, 448
    s_add_u32 s12, s12, 145408
    v_add_u32 v7, s12, v7
    v_lshlrev_b32 v9, 4, v1
    s_lshl_b32 s12, s3, 9
    s_add_u32 s12, s12, 32768
    v_add_u32 v10, s12, v9
    v_bfe_u32 v3, v1, 3, 1
    v_lshlrev_b32 v3, 10, v3
    v_and_b32 v6, 3, v1
    v_lshl_add_u32 v3, v6, 6, v3
    v_lshrrev_b32 v6, 4, v1
    v_lshl_add_u32 v3, v6, 4, v3
    v_bfe_u32 v6, v1, 2, 1
    v_lshl_add_u32 v3, v6, 2, v3
    v_add_u32 v3, 32768, v3
    v_lshlrev_b32 v5, 3, v6
    v_add_u32 v5, 163536, v5
    s_lshl_b32 s14, s62, 8
    s_lshr_b32 s13, s9, 1
    s_mul_i32 s13, s13, 14336
    s_add_u32 s14, s14, s13
    s_add_u32 s14, s14, 98304
    v_mov_b32 v129, s11
    v_mov_b32 v131, s11
    v_and_b32 v48, 31, v1
    v_lshlrev_b32 v48, 4, v48
    v_lshrrev_b32 v6, 5, v1
    v_lshl_add_u32 v49, v6, 10, v48
    v_bfe_u32 v50, v1, 4, 1
    v_mul_u32_u24 v50, 928, v50
    v_and_b32 v51, 15, v1
    v_lshl_add_u32 v50, v51, 2, v50
    s_and_b32 s12, s3, 1
    s_mul_i32 s13, s12, 448
    s_add_u32 s13, s13, 145408
    v_add_u32 v50, s13, v50
    v_lshl_add_u32 v51, v6, 6, v50
    s_mul_i32 s61, s4, 14
    s_mul_i32 s12, s12, 7
    s_add_u32 s61, s61, s12
    s_lshl_b32 s61, s61, 10
    s_add_u32 s61, s61, 557056
    s_waitcnt vmcnt(0)
    s_barrier
    ds_read_b64_tr_b16 v[16:17], v8 offset:0
    ds_read_b64_tr_b16 v[18:19], v8 offset:1024
    ds_read_b64_tr_b16 v[20:21], v8 offset:2048
    ds_read_b64_tr_b16 v[22:23], v8 offset:3072
    ds_read_b64_tr_b16 v[24:25], v8 offset:4096
    ds_read_b64_tr_b16 v[26:27], v8 offset:5120
    ds_read_b64_tr_b16 v[28:29], v8 offset:6144
    ds_read_b64_tr_b16 v[30:31], v8 offset:7168
    ds_read_b64_tr_b16 v[32:33], v8 offset:8192
    ds_read_b64_tr_b16 v[34:35], v8 offset:9216
    ds_read_b64_tr_b16 v[36:37], v8 offset:10240
    ds_read_b64_tr_b16 v[38:39], v8 offset:11264
    ds_read_b64_tr_b16 v[40:41], v8 offset:12288
    ds_read_b64_tr_b16 v[42:43], v8 offset:13312
    s_waitcnt lgkmcnt(0)
    s_add_u32 s12, s61, 4096
    s_mov_b32 s15, 32767
Lpoll_47:
    buffer_load_dwordx4 v[136:139], v49, s[52:55], s61 offen offset:0 sc1
    buffer_load_dwordx4 v[140:143], v49, s[52:55], s61 offen offset:2048 sc1
    buffer_load_dwordx4 v[144:147], v49, s[52:55], s12 offen offset:0 sc1
    buffer_load_dwordx4 v[148:151], v48, s[52:55], s12 offen offset:2048 sc1
    s_waitcnt vmcnt(0)
    v_xor_b32 v6, s11, v137
    v_bitop3_b32 v6, v6, v139, s11 bitop3:0xf6
    v_bitop3_b32 v6, v6, v141, s11 bitop3:0xf6
    v_bitop3_b32 v6, v6, v143, s11 bitop3:0xf6
    v_bitop3_b32 v6, v6, v145, s11 bitop3:0xf6
    v_bitop3_b32 v6, v6, v147, s11 bitop3:0xf6
    v_bitop3_b32 v6, v6, v149, s11 bitop3:0xf6
    v_bitop3_b32 v6, v6, v151, s11 bitop3:0xf6
    v_cmp_ne_u32 vcc, 0, v6
    s_nop 0
    s_cbranch_vccz Lpolld_48
    s_sub_u32 s15, s15, 1
    s_cmp_lg_u32 s15, 0
    s_cbranch_scc1 Lpoll_47
Lpolld_48:
    ds_write_b32 v51, v136 offset:0
    ds_write_b32 v51, v138 offset:1856
    ds_write_b32 v51, v140 offset:128
    ds_write_b32 v51, v142 offset:1984
    ds_write_b32 v51, v144 offset:256
    ds_write_b32 v51, v146 offset:2112
    ds_write_b32 v50, v148 offset:384
    ds_write_b32 v50, v150 offset:2240
    ds_read2_b64 v[72:75], v7 offset0:0 offset1:4
    ds_read2_b64 v[76:79], v7 offset0:8 offset1:12
    ds_read2_b64 v[80:83], v7 offset0:16 offset1:20
    ds_read2_b64 v[84:87], v7 offset0:24 offset1:28
    ds_read2_b64 v[88:91], v7 offset0:32 offset1:36
    ds_read2_b64 v[92:95], v7 offset0:40 offset1:44
    ds_read2_b64 v[96:99], v7 offset0:48 offset1:52
    s_waitcnt lgkmcnt(6)
    v_mfma_f32_16x16x32_bf16 v[12:15], v[72:75], v[16:19], 0
    s_waitcnt lgkmcnt(5)
    v_mfma_f32_16x16x32_bf16 v[12:15], v[76:79], v[20:23], v[12:15]
    s_waitcnt lgkmcnt(4)
    v_mfma_f32_16x16x32_bf16 v[12:15], v[80:83], v[24:27], v[12:15]
    s_waitcnt lgkmcnt(3)
    v_mfma_f32_16x16x32_bf16 v[12:15], v[84:87], v[28:31], v[12:15]
    s_waitcnt lgkmcnt(2)
    v_mfma_f32_16x16x32_bf16 v[12:15], v[88:91], v[32:35], v[12:15]
    s_waitcnt lgkmcnt(1)
    v_mfma_f32_16x16x32_bf16 v[12:15], v[92:95], v[36:39], v[12:15]
    s_waitcnt lgkmcnt(0)
    v_mfma_f32_16x16x32_bf16 v[12:15], v[96:99], v[40:43], v[12:15]
    s_mov_b32 exec_hi, 0
    s_nop 6
    ds_write_b128 v10, v[12:15]
    s_mov_b64 exec, -1
    s_waitcnt lgkmcnt(0)
    s_barrier
    s_cmp_lg_u32 s3, 0
    s_cbranch_scc1 L_hend
    ds_read2_b32 v[82:83], v3 offset0:0 offset1:2
    ds_read2_b32 v[84:85], v3 offset0:64 offset1:66
    ds_read2_b32 v[86:87], v3 offset0:128 offset1:130
    ds_read2_b32 v[88:89], v3 offset0:192 offset1:194
    ds_read_b64 v[72:73], v5
    s_waitcnt lgkmcnt(1)
    v_add_f32 v10, v82, v86
    v_add_f32 v11, v83, v87
    v_add_f32 v12, v84, v88
    v_add_f32 v13, v85, v89
    v_add_f32 v10, v10, v11
    s_waitcnt lgkmcnt(0)
    v_fma_f32 v10, -v72, v12, v10
    v_fma_f32 v10, v10, v73, v13
    s_cmp_ge_u32 s9, 2
    s_cbranch_scc1 L_gu_up
    v_cvt_pk_bf16_f32 v10, v10, v10
    v_lshlrev_b32 v10, 16, v10
    v_mul_f32 v7, 0xbfb8aa3b, v10
    v_exp_f32 v7, v7
    s_nop 0
    v_add_f32 v7, 1.0, v7
    v_rcp_f32 v7, v7
    s_nop 0
    v_mul_f32 v10, v10, v7
L_gu_up:
    v_mov_b32 v11, v10
    s_nop 1
    v_permlane16_swap_b32 v10, v11
    v_cvt_pk_bf16_f32 v128, v10, v11
    v_cvt_pk_bf16_f32 v130, v10, v11
    s_nop 1
    v_permlane32_swap_b32 v128, v130
    s_mov_b32 exec_lo, 0xffff
    s_mov_b32 exec_hi, 0
    buffer_store_dwordx4 v[128:131], v9, s[52:55], s14 offen sc1
    s_mov_b64 exec, -1
    s_branch L_hend
L_post_dn:
    s_mov_b32 s56, s32
    s_mov_b32 s57, s33
    s_mov_b32 s58, 1605632
    s_mov_b32 s59, 0x20000
    s_lshl_b32 s14, s9, 2
    s_add_u32 s14, s14, s3
    s_mul_i32 s14, s14, 100352
    s_lshl_b32 s13, s4, 7
    s_add_u32 s14, s14, s13
    s_mul_i32 s60, s3, 14336
    s_add_u32 s60, s60, 16384
    v_lshrrev_b32 v4, 3, v1
    v_mul_u32_u24 v4, 896, v4
    v_lshrrev_b32 v6, 3, v1
    v_and_b32 v6, 6, v6
    v_xor_b32 v6, v6, v1
    v_and_b32 v6, 7, v6
    v_lshl_add_u32 v4, v6, 4, v4
    s_add_u32 s13, s14, 0
    s_add_u32 m0, s60, 0
    s_nop 0
    buffer_load_dwordx4 v4, s[56:59], s13 offen nt lds
    s_add_u32 s13, s14, 7168
    s_add_u32 m0, s60, 1024
    s_nop 0
    buffer_load_dwordx4 v4, s[56:59], s13 offen nt lds
    s_add_u32 s13, s14, 14336
    s_add_u32 m0, s60, 2048
    s_nop 0
    buffer_load_dwordx4 v4, s[56:59], s13 offen nt lds
    s_add_u32 s13, s14, 21504
    s_add_u32 m0, s60, 3072
    s_nop 0
    buffer_load_dwordx4 v4, s[56:59], s13 offen nt lds
    s_add_u32 s13, s14, 28672
    s_add_u32 m0, s60, 4096
    s_nop 0
    buffer_load_dwordx4 v4, s[56:59], s13 offen nt lds
    s_add_u32 s13, s14, 35840
    s_add_u32 m0, s60, 5120
    s_nop 0
    buffer_load_dwordx4 v4, s[56:59], s13 offen nt lds
    s_add_u32 s13, s14, 43008
    s_add_u32 m0, s60, 6144
    s_nop 0
    buffer_load_dwordx4 v4, s[56:59], s13 offen nt lds
    s_add_u32 s13, s14, 50176
    s_add_u32 m0, s60, 7168
    s_nop 0
    buffer_load_dwordx4 v4, s[56:59], s13 offen nt lds
    s_add_u32 s13, s14, 57344
    s_add_u32 m0, s60, 8192
    s_nop 0
    buffer_load_dwordx4 v4, s[56:59], s13 offen nt lds
    s_add_u32 s13, s14, 64512
    s_add_u32 m0, s60, 9216
    s_nop 0
    buffer_load_dwordx4 v4, s[56:59], s13 offen nt lds
    s_add_u32 s13, s14, 71680
    s_add_u32 m0, s60, 10240
    s_nop 0
    buffer_load_dwordx4 v4, s[56:59], s13 offen nt lds
    s_add_u32 s13, s14, 78848
    s_add_u32 m0, s60, 11264
    s_nop 0
    buffer_load_dwordx4 v4, s[56:59], s13 offen nt lds
    s_add_u32 s13, s14, 86016
    s_add_u32 m0, s60, 12288
    s_nop 0
    buffer_load_dwordx4 v4, s[56:59], s13 offen nt lds
    s_add_u32 s13, s14, 93184
    s_add_u32 m0, s60, 13312
    s_nop 0
    buffer_load_dwordx4 v4, s[56:59], s13 offen nt lds
    v_lshrrev_b32 v5, 2, v1
    v_lshlrev_b32 v5, 7, v5
    v_and_b32 v6, 3, v1
    v_lshl_add_u32 v5, v6, 3, v5
    v_bfe_u32 v6, v1, 3, 2
    v_xor_b32 v6, s3, v6
    v_lshl_add_u32 v5, v6, 5, v5
    v_add_u32 v5, 16384, v5
    v_and_b32 v7, 1, v1
    v_mul_u32_u24 v7, 928, v7
    v_lshrrev_b32 v6, 4, v1
    v_lshl_add_u32 v7, v6, 3, v7
    v_add_u32 v7, 0, v7
    v_lshlrev_b32 v9, 4, v1
    s_lshl_b32 s12, s4, 2
    s_add_u32 s12, s12, s3
    s_lshl_b32 s12, s12, 2
    s_add_u32 s12, s12, s9
    s_lshl_b32 s12, s12, 8
    s_add_u32 s12, s12, 786432
    v_mov_b32 v6, 163528
    ds_read_b32 v8, v6
    v_mov_b32 v129, s11
    v_mov_b32 v131, s11
    s_waitcnt vmcnt(0) lgkmcnt(0)
    v_readfirstlane_b32 s42, v8
    s_barrier
    ds_read_b64_tr_b16 v[16:17], v5 offset:0
    ds_read_b64_tr_b16 v[18:19], v5 offset:2048
    ds_read_b64_tr_b16 v[20:21], v5 offset:4096
    ds_read_b64_tr_b16 v[22:23], v5 offset:6144
    ds_read_b64_tr_b16 v[24:25], v5 offset:8192
    ds_read_b64_tr_b16 v[26:27], v5 offset:10240
    ds_read_b64_tr_b16 v[28:29], v5 offset:12288
    ds_read_b64_tr_b16 v[30:31], v5 offset:14336
    ds_read_b64_tr_b16 v[32:33], v5 offset:16384
    ds_read_b64_tr_b16 v[34:35], v5 offset:18432
    ds_read_b64_tr_b16 v[36:37], v5 offset:20480
    ds_read_b64_tr_b16 v[38:39], v5 offset:22528
    ds_read_b64_tr_b16 v[40:41], v5 offset:24576
    ds_read_b64_tr_b16 v[42:43], v5 offset:26624
    ds_read_b64_tr_b16 v[44:45], v5 offset:28672
    ds_read_b64_tr_b16 v[46:47], v5 offset:30720
    ds_read_b64_tr_b16 v[48:49], v5 offset:32768
    ds_read_b64_tr_b16 v[50:51], v5 offset:34816
    ds_read_b64_tr_b16 v[52:53], v5 offset:36864
    ds_read_b64_tr_b16 v[54:55], v5 offset:38912
    ds_read_b64_tr_b16 v[56:57], v5 offset:40960
    ds_read_b64_tr_b16 v[58:59], v5 offset:43008
    ds_read_b64_tr_b16 v[60:61], v5 offset:45056
    ds_read_b64_tr_b16 v[62:63], v5 offset:47104
    ds_read_b64_tr_b16 v[64:65], v5 offset:49152
    ds_read_b64_tr_b16 v[66:67], v5 offset:51200
    ds_read_b64_tr_b16 v[68:69], v5 offset:53248
    ds_read_b64_tr_b16 v[70:71], v5 offset:55296
    s_waitcnt lgkmcnt(0)
    s_barrier
    ds_read2_b64 v[72:75], v7 offset0:0 offset1:4
    ds_read2_b64 v[76:79], v7 offset0:8 offset1:12
    ds_read2_b64 v[80:83], v7 offset0:16 offset1:20
    ds_read2_b64 v[84:87], v7 offset0:24 offset1:28
    ds_read2_b64 v[88:91], v7 offset0:32 offset1:36
    ds_read2_b64 v[92:95], v7 offset0:40 offset1:44
    ds_read2_b64 v[96:99], v7 offset0:48 offset1:52
    ds_read2_b64 v[100:103], v7 offset0:56 offset1:60
    ds_read2_b64 v[104:107], v7 offset0:64 offset1:68
    ds_read2_b64 v[108:111], v7 offset0:72 offset1:76
    ds_read2_b64 v[112:115], v7 offset0:80 offset1:84
    ds_read2_b64 v[116:119], v7 offset0:88 offset1:92
    ds_read2_b64 v[120:123], v7 offset0:96 offset1:100
    ds_read2_b64 v[124:127], v7 offset0:104 offset1:108
    s_waitcnt lgkmcnt(13)
    v_mfma_f32_16x16x32_bf16 v[12:15], v[72:75], v[16:19], 0
    s_waitcnt lgkmcnt(12)
    v_mfma_f32_16x16x32_bf16 v[12:15], v[76:79], v[20:23], v[12:15]
    s_waitcnt lgkmcnt(11)
    v_mfma_f32_16x16x32_bf16 v[12:15], v[80:83], v[24:27], v[12:15]
    s_waitcnt lgkmcnt(10)
    v_mfma_f32_16x16x32_bf16 v[12:15], v[84:87], v[28:31], v[12:15]
    s_waitcnt lgkmcnt(9)
    v_mfma_f32_16x16x32_bf16 v[12:15], v[88:91], v[32:35], v[12:15]
    s_waitcnt lgkmcnt(8)
    v_mfma_f32_16x16x32_bf16 v[12:15], v[92:95], v[36:39], v[12:15]
    s_waitcnt lgkmcnt(7)
    v_mfma_f32_16x16x32_bf16 v[12:15], v[96:99], v[40:43], v[12:15]
    s_waitcnt lgkmcnt(6)
    v_mfma_f32_16x16x32_bf16 v[12:15], v[100:103], v[44:47], v[12:15]
    s_waitcnt lgkmcnt(5)
    v_mfma_f32_16x16x32_bf16 v[12:15], v[104:107], v[48:51], v[12:15]
    s_waitcnt lgkmcnt(4)
    v_mfma_f32_16x16x32_bf16 v[12:15], v[108:111], v[52:55], v[12:15]
    s_waitcnt lgkmcnt(3)
    v_mfma_f32_16x16x32_bf16 v[12:15], v[112:115], v[56:59], v[12:15]
    s_waitcnt lgkmcnt(2)
    v_mfma_f32_16x16x32_bf16 v[12:15], v[116:119], v[60:63], v[12:15]
    s_waitcnt lgkmcnt(1)
    v_mfma_f32_16x16x32_bf16 v[12:15], v[120:123], v[64:67], v[12:15]
    s_waitcnt lgkmcnt(0)
    v_mfma_f32_16x16x32_bf16 v[12:15], v[124:127], v[68:71], v[12:15]
    s_mov_b32 exec_lo, 0xffff
    s_mov_b32 exec_hi, 0
    s_nop 5
    v_mov_b32 v128, v12
    v_mov_b32 v130, v13
    s_cmp_lg_u32 s42, 1
    s_cbranch_scc1 Lsg_49
    buffer_store_dwordx4 v[128:131], v9, s[52:55], s12 offen
Lsd_50:
    s_mov_b64 exec, -1
L_hend:
    s_endpgm
L_att:
    s_sub_u32 s3, s3, 4
    s_lshl_b32 s14, s3, 14
    v_and_b32 v6, 15, v1
    v_and_b32 v7, 7, v1
    v_lshlrev_b32 v7, 1, v7
    v_lshrrev_b32 v8, 4, v1
    v_xor_b32 v7, v7, v8
    v_lshlrev_b32 v7, 4, v7
    v_lshl_add_u32 v7, v6, 9, v7
    v_add_u32 v8, s14, v7
    v_xor_b32 v9, 64, v8
    v_xor_b32 v10, 128, v8
    v_xor_b32 v11, 192, v8
    s_lshl_b32 s13, s3, 2
    s_add_u32 s13, s13, 163472
    v_mov_b32 v5, s13
    s_add_u32 s12, s3, 1
    s_barrier
    s_mov_b32 s18, 0x30003
    s_mov_b32 s19, 0x30003
    s_mov_b32 s20, 0xc000c
    s_mov_b32 s21, 0xc000c
    s_mov_b32 s22, 0x300030
    s_mov_b32 s23, 0x300030
    s_mov_b32 s24, 0xc000c0
    s_mov_b32 s25, 0xc000c0
    s_mov_b32 s26, 0x3000300
    s_mov_b32 s27, 0x3000300
    s_mov_b32 s28, 0xc000c00
    s_mov_b32 s29, 0xc000c00
    s_mov_b32 s30, 0x30003000
    s_mov_b32 s31, 0x30003000
    s_mov_b32 s32, 0xc000c000
    s_mov_b32 s33, 0xc000c000
    s_mov_b32 s15, 262136
    v_mov_b32 v6, 163464
Lw_51:
    ds_read_b32 v7, v6
    s_waitcnt lgkmcnt(0)
    v_readfirstlane_b32 s13, v7
    s_nop 0
    s_cmp_ge_u32 s13, s12
    s_nop 1
    s_cbranch_scc1 Lwd_52
    s_sleep 4
    s_sub_u32 s15, s15, 1
    s_cmp_lg_u32 s15, 0
    s_cbranch_scc1 Lw_51
Lwd_52:
    s_add_u32 s12, s12, 8
    ds_read_b128 v[16:19], v8 offset:0
    ds_read_b128 v[20:23], v9 offset:0
    ds_read_b128 v[24:27], v10 offset:0
    ds_read_b128 v[28:31], v11 offset:0
    ds_read_b128 v[32:35], v8 offset:256
    ds_read_b128 v[36:39], v9 offset:256
    ds_read_b128 v[40:43], v10 offset:256
    ds_read_b128 v[44:47], v11 offset:256
    s_waitcnt lgkmcnt(0)
    v_mov_b32 v6, 1
    ds_write_b32 v5, v6
    s_mov_b32 s15, 262136
    v_mov_b32 v6, 163464
Lw_53:
    ds_read_b32 v7, v6
    s_waitcnt lgkmcnt(0)
    v_readfirstlane_b32 s13, v7
    s_nop 0
    s_cmp_ge_u32 s13, s12
    s_nop 1
    s_cbranch_scc1 Lwd_54
    s_sleep 4
    s_sub_u32 s15, s15, 1
    s_cmp_lg_u32 s15, 0
    s_cbranch_scc1 Lw_53
Lwd_54:
    s_add_u32 s12, s12, 8
    ds_read_b128 v[48:51], v8 offset:8192
    ds_read_b128 v[52:55], v9 offset:8192
    ds_read_b128 v[56:59], v10 offset:8192
    ds_read_b128 v[60:63], v11 offset:8192
    ds_read_b128 v[64:67], v8 offset:8448
    ds_read_b128 v[68:71], v9 offset:8448
    ds_read_b128 v[72:75], v10 offset:8448
    ds_read_b128 v[76:79], v11 offset:8448
    s_waitcnt lgkmcnt(0)
    v_mov_b32 v6, 2
    ds_write_b32 v5, v6
    s_cmp_lg_u32 s3, 1
    s_cbranch_scc1 Lck_55
    s_memrealtime s[100:101]
    v_mov_b32 v6, 163516
    ds_read_b32 v7, v6
    s_waitcnt lgkmcnt(0)
    v_readfirstlane_b32 s60, v7
    s_nop 0
    s_cmp_eq_u32 s60, 0
    s_nop 1
    s_cbranch_scc1 Lck_55
    s_sub_u32 s60, s100, s60
    s_mov_b32 s61, 1
    s_cmp_ge_u32 s60, 447
    s_addc_u32 s61, s61, 0
    s_cmp_ge_u32 s60, 497
    s_addc_u32 s61, s61, 0
    s_cmp_ge_u32 s60, 537
    s_addc_u32 s61, s61, 0
    s_cmp_ge_u32 s60, 587
    s_addc_u32 s61, s61, 0
    v_mov_b32 v6, 163512
    v_mov_b32 v7, s61
    ds_write_b32 v6, v7
Lck_55:
    s_cmp_lg_u32 s3, 5
    s_cbranch_scc1 Lck_56
    s_memrealtime s[100:101]
    v_mov_b32 v6, 163516
    ds_read_b32 v7, v6
    s_waitcnt lgkmcnt(0)
    v_readfirstlane_b32 s60, v7
    s_nop 0
    s_cmp_eq_u32 s60, 0
    s_nop 1
    s_cbranch_scc1 Lck_56
    s_sub_u32 s60, s100, s60
    s_mov_b32 s61, 1
    s_cmp_ge_u32 s60, 575
    s_addc_u32 s61, s61, 0
    s_cmp_ge_u32 s60, 625
    s_addc_u32 s61, s61, 0
    s_cmp_ge_u32 s60, 665
    s_addc_u32 s61, s61, 0
    s_cmp_ge_u32 s60, 715
    s_addc_u32 s61, s61, 0
    v_mov_b32 v6, 163512
    v_mov_b32 v7, s61
    ds_write_b32 v6, v7
Lck_56:
    s_mov_b32 s15, 262136
    v_mov_b32 v6, 163464
Lw_57:
    ds_read_b32 v7, v6
    s_waitcnt lgkmcnt(0)
    v_readfirstlane_b32 s13, v7
    s_nop 0
    s_cmp_ge_u32 s13, s12
    s_nop 1
    s_cbranch_scc1 Lwd_58
    s_sleep 4
    s_sub_u32 s15, s15, 1
    s_cmp_lg_u32 s15, 0
    s_cbranch_scc1 Lw_57
Lwd_58:
    s_add_u32 s12, s12, 8
    ds_read_b128 v[80:83], v8 offset:0
    ds_read_b128 v[84:87], v9 offset:0
    ds_read_b128 v[88:91], v10 offset:0
    ds_read_b128 v[92:95], v11 offset:0
    ds_read_b128 v[96:99], v8 offset:256
    ds_read_b128 v[100:103], v9 offset:256
    ds_read_b128 v[104:107], v10 offset:256
    ds_read_b128 v[108:111], v11 offset:256
    s_waitcnt lgkmcnt(0)
    v_mov_b32 v6, 3
    ds_write_b32 v5, v6
    s_cmp_lg_u32 s3, 1
    s_cbranch_scc1 Lck_59
    s_memrealtime s[100:101]
    v_mov_b32 v6, 163516
    ds_read_b32 v7, v6
    s_waitcnt lgkmcnt(0)
    v_readfirstlane_b32 s60, v7
    s_nop 0
    s_cmp_eq_u32 s60, 0
    s_nop 1
    s_cbranch_scc1 Lck_59
    s_sub_u32 s60, s100, s60
    s_mov_b32 s61, 1
    s_cmp_ge_u32 s60, 703
    s_addc_u32 s61, s61, 0
    s_cmp_ge_u32 s60, 753
    s_addc_u32 s61, s61, 0
    s_cmp_ge_u32 s60, 793
    s_addc_u32 s61, s61, 0
    s_cmp_ge_u32 s60, 843
    s_addc_u32 s61, s61, 0
    v_mov_b32 v6, 163512
    v_mov_b32 v7, s61
    ds_write_b32 v6, v7
Lck_59:
    s_cmp_lg_u32 s3, 5
    s_cbranch_scc1 Lck_60
    s_memrealtime s[100:101]
    v_mov_b32 v6, 163516
    ds_read_b32 v7, v6
    s_waitcnt lgkmcnt(0)
    v_readfirstlane_b32 s60, v7
    s_nop 0
    s_cmp_eq_u32 s60, 0
    s_nop 1
    s_cbranch_scc1 Lck_60
    s_sub_u32 s60, s100, s60
    s_mov_b32 s61, 1
    s_cmp_ge_u32 s60, 830
    s_addc_u32 s61, s61, 0
    s_cmp_ge_u32 s60, 880
    s_addc_u32 s61, s61, 0
    s_cmp_ge_u32 s60, 920
    s_addc_u32 s61, s61, 0
    s_cmp_ge_u32 s60, 970
    s_addc_u32 s61, s61, 0
    v_mov_b32 v6, 163512
    v_mov_b32 v7, s61
    ds_write_b32 v6, v7
Lck_60:
    s_mov_b32 s15, 262136
    v_mov_b32 v6, 163464
Lw_61:
    ds_read_b32 v7, v6
    s_waitcnt lgkmcnt(0)
    v_readfirstlane_b32 s13, v7
    s_nop 0
    s_cmp_ge_u32 s13, s12
    s_nop 1
    s_cbranch_scc1 Lwd_62
    s_sleep 4
    s_sub_u32 s15, s15, 1
    s_cmp_lg_u32 s15, 0
    s_cbranch_scc1 Lw_61
Lwd_62:
    s_add_u32 s12, s12, 8
    ds_read_b128 v[112:115], v8 offset:8192
    ds_read_b128 v[116:119], v9 offset:8192
    ds_read_b128 v[120:123], v10 offset:8192
    ds_read_b128 v[124:127], v11 offset:8192
    ds_read_b128 v[128:131], v8 offset:8448
    ds_read_b128 v[132:135], v9 offset:8448
    ds_read_b128 v[136:139], v10 offset:8448
    ds_read_b128 v[140:143], v11 offset:8448
    s_waitcnt lgkmcnt(0)
    v_mov_b32 v6, 4
    ds_write_b32 v5, v6
    s_cmp_lg_u32 s3, 1
    s_cbranch_scc1 Lck_63
    s_memrealtime s[100:101]
    v_mov_b32 v6, 163516
    ds_read_b32 v7, v6
    s_waitcnt lgkmcnt(0)
    v_readfirstlane_b32 s60, v7
    s_nop 0
    s_cmp_eq_u32 s60, 0
    s_nop 1
    s_cbranch_scc1 Lck_63
    s_sub_u32 s60, s100, s60
    s_mov_b32 s61, 1
    s_cmp_ge_u32 s60, 958
    s_addc_u32 s61, s61, 0
    s_cmp_ge_u32 s60, 1008
    s_addc_u32 s61, s61, 0
    s_cmp_ge_u32 s60, 1048
    s_addc_u32 s61, s61, 0
    s_cmp_ge_u32 s60, 1098
    s_addc_u32 s61, s61, 0
    v_mov_b32 v6, 163512
    v_mov_b32 v7, s61
    ds_write_b32 v6, v7
Lck_63:
    s_cmp_lg_u32 s3, 6
    s_cbranch_scc1 Lck_64
    s_memrealtime s[100:101]
    v_mov_b32 v6, 163516
    ds_read_b32 v7, v6
    s_waitcnt lgkmcnt(0)
    v_readfirstlane_b32 s60, v7
    s_nop 0
    s_cmp_eq_u32 s60, 0
    s_nop 1
    s_cbranch_scc1 Lck_64
    s_sub_u32 s60, s100, s60
    s_mov_b32 s61, 1
    s_cmp_ge_u32 s60, 1114
    s_addc_u32 s61, s61, 0
    s_cmp_ge_u32 s60, 1164
    s_addc_u32 s61, s61, 0
    s_cmp_ge_u32 s60, 1204
    s_addc_u32 s61, s61, 0
    s_cmp_ge_u32 s60, 1254
    s_addc_u32 s61, s61, 0
    v_mov_b32 v6, 163512
    v_mov_b32 v7, s61
    ds_write_b32 v6, v7
Lck_64:
    v_and_b32 v2, 1, v1
    v_lshlrev_b32 v2, 9, v2
    v_lshrrev_b32 v7, 4, v1
    v_lshl_add_u32 v2, v7, 4, v2
    v_add_u32 v2, 161536, v2
    s_mov_b32 s15, 262136
    v_mov_b32 v6, 163456
Lw_65:
    ds_read_b32 v7, v6
    s_waitcnt lgkmcnt(0)
    v_readfirstlane_b32 s13, v7
    s_nop 0
    s_cmp_ge_u32 s13, 1
    s_nop 1
    s_cbranch_scc1 Lwd_66
    s_sleep 2
    s_sub_u32 s15, s15, 1
    s_cmp_lg_u32 s15, 0
    s_cbranch_scc1 Lw_65
Lwd_66:
    v_mov_b32 v7, 163460
    ds_read_b32 v7, v7
    ds_read_b128 v[160:163], v2
    ds_read_b128 v[164:167], v2 offset:64
    s_waitcnt lgkmcnt(1)
    v_mfma_f32_16x16x32_bf16 v[144:147], v[16:19], v[160:163], 0
    v_mfma_f32_16x16x32_bf16 v[148:151], v[48:51], v[160:163], 0
    v_mfma_f32_16x16x32_bf16 v[152:155], v[80:83], v[160:163], 0
    v_mfma_f32_16x16x32_bf16 v[156:159], v[112:115], v[160:163], 0
    ds_read_b128 v[160:163], v2 offset:128
    s_waitcnt lgkmcnt(1)
    v_mfma_f32_16x16x32_bf16 v[144:147], v[20:23], v[164:167], v[144:147]
    v_mfma_f32_16x16x32_bf16 v[148:151], v[52:55], v[164:167], v[148:151]
    v_mfma_f32_16x16x32_bf16 v[152:155], v[84:87], v[164:167], v[152:155]
    v_mfma_f32_16x16x32_bf16 v[156:159], v[116:119], v[164:167], v[156:159]
    ds_read_b128 v[164:167], v2 offset:192
    s_waitcnt lgkmcnt(1)
    v_mfma_f32_16x16x32_bf16 v[144:147], v[24:27], v[160:163], v[144:147]
    v_mfma_f32_16x16x32_bf16 v[148:151], v[56:59], v[160:163], v[148:151]
    v_mfma_f32_16x16x32_bf16 v[152:155], v[88:91], v[160:163], v[152:155]
    v_mfma_f32_16x16x32_bf16 v[156:159], v[120:123], v[160:163], v[156:159]
    ds_read_b128 v[160:163], v2 offset:256
    s_waitcnt lgkmcnt(1)
    v_mfma_f32_16x16x32_bf16 v[144:147], v[28:31], v[164:167], v[144:147]
    v_mfma_f32_16x16x32_bf16 v[148:151], v[60:63], v[164:167], v[148:151]
    v_mfma_f32_16x16x32_bf16 v[152:155], v[92:95], v[164:167], v[152:155]
    v_mfma_f32_16x16x32_bf16 v[156:159], v[124:127], v[164:167], v[156:159]
    ds_read_b128 v[164:167], v2 offset:320
    s_waitcnt lgkmcnt(1)
    v_mfma_f32_16x16x32_bf16 v[144:147], v[32:35], v[160:163], v[144:147]
    v_mfma_f32_16x16x32_bf16 v[148:151], v[64:67], v[160:163], v[148:151]
    v_mfma_f32_16x16x32_bf16 v[152:155], v[96:99], v[160:163], v[152:155]
    v_mfma_f32_16x16x32_bf16 v[156:159], v[128:131], v[160:163], v[156:159]
    ds_read_b128 v[160:163], v2 offset:384
    s_waitcnt lgkmcnt(1)
    v_mfma_f32_16x16x32_bf16 v[144:147], v[36:39], v[164:167], v[144:147]
    v_mfma_f32_16x16x32_bf16 v[148:151], v[68:71], v[164:167], v[148:151]
    v_mfma_f32_16x16x32_bf16 v[152:155], v[100:103], v[164:167], v[152:155]
    v_mfma_f32_16x16x32_bf16 v[156:159], v[132:135], v[164:167], v[156:159]
    ds_read_b128 v[164:167], v2 offset:448
    s_waitcnt lgkmcnt(1)
    v_mfma_f32_16x16x32_bf16 v[144:147], v[40:43], v[160:163], v[144:147]
    v_mfma_f32_16x16x32_bf16 v[148:151], v[72:75], v[160:163], v[148:151]
    v_mfma_f32_16x16x32_bf16 v[152:155], v[104:107], v[160:163], v[152:155]
    v_mfma_f32_16x16x32_bf16 v[156:159], v[136:139], v[160:163], v[156:159]
    s_waitcnt lgkmcnt(0)
    v_mfma_f32_16x16x32_bf16 v[144:147], v[44:47], v[164:167], v[144:147]
    v_mfma_f32_16x16x32_bf16 v[148:151], v[76:79], v[164:167], v[148:151]
    v_mfma_f32_16x16x32_bf16 v[152:155], v[108:111], v[164:167], v[152:155]
    v_mfma_f32_16x16x32_bf16 v[156:159], v[140:143], v[164:167], v[156:159]
    v_readfirstlane_b32 s11, v7
    v_lshrrev_b32 v6, 2, v1
    v_and_b32 v7, 7, v6
    v_lshlrev_b32 v7, 1, v7
    v_bfe_u32 v8, v1, 1, 1
    v_xor_b32 v7, v7, v8
    v_lshlrev_b32 v7, 4, v7
    v_lshl_add_u32 v7, v6, 9, v7
    v_and_b32 v6, 1, v1
    v_lshl_add_u32 v7, v6, 3, v7
    v_add_u32 v8, s14, v7
    v_xor_b32 v9, 32, v8
    v_xor_b32 v10, 64, v8
    v_xor_b32 v11, 96, v8
    v_xor_b32 v12, 128, v8
    v_xor_b32 v13, 160, v8
    v_xor_b32 v14, 192, v8
    v_xor_b32 v15, 224, v8
    v_lshlrev_b32 v3, 5, v6
    v_add_u32 v3, 163328, v3
    s_lshl_b32 s13, s3, 2
    v_add_u32 v4, s13, v3
    v_cvt_pk_bf16_f32 v6, v144, v145
    v_lshlrev_b32 v144, 16, v6
    v_and_b32 v145, 0xffff0000, v6
    v_cvt_pk_bf16_f32 v7, v146, v147
    v_lshlrev_b32 v146, 16, v7
    v_and_b32 v147, 0xffff0000, v7
    v_cvt_pk_bf16_f32 v6, v148, v149
    v_lshlrev_b32 v148, 16, v6
    v_and_b32 v149, 0xffff0000, v6
    v_cvt_pk_bf16_f32 v7, v150, v151
    v_lshlrev_b32 v150, 16, v7
    v_and_b32 v151, 0xffff0000, v7
    v_cvt_pk_bf16_f32 v6, v152, v153
    v_lshlrev_b32 v152, 16, v6
    v_and_b32 v153, 0xffff0000, v6
    v_cvt_pk_bf16_f32 v7, v154, v155
    v_lshlrev_b32 v154, 16, v7
    v_and_b32 v155, 0xffff0000, v7
    v_cvt_pk_bf16_f32 v6, v156, v157
    v_lshlrev_b32 v156, 16, v6
    v_and_b32 v157, 0xffff0000, v6
    v_cvt_pk_bf16_f32 v7, v158, v159
    v_lshlrev_b32 v158, 16, v7
    v_and_b32 v159, 0xffff0000, v7
    v_max3_f32 v120, v144, v145, v146
    v_max3_f32 v120, v120, v147, v148
    v_max3_f32 v120, v120, v149, v150
    v_max3_f32 v120, v120, v151, v152
    v_max3_f32 v120, v120, v153, v154
    v_max3_f32 v120, v120, v155, v156
    v_max3_f32 v120, v120, v157, v158
    v_max_f32 v120, v120, v159
    v_mov_b32 v6, v120
    s_nop 1
    v_permlane16_swap_b32 v120, v6
    v_max_f32 v120, v120, v6
    v_mov_b32 v6, v120
    s_nop 1
    v_permlane32_swap_b32 v120, v6
    v_max_f32 v120, v120, v6
    v_mov_b32 v6, 163504
    v_mov_b32 v7, 1
    s_mov_b64 exec, 3
    ds_write_b32 v4, v120
    s_mov_b64 exec, 1
    ds_add_u32 v6, v7
    s_mov_b64 exec, -1
    s_mov_b32 s15, 262136
    v_mov_b32 v6, 163504
Lw_67:
    ds_read_b32 v7, v6
    s_waitcnt lgkmcnt(0)
    v_readfirstlane_b32 s13, v7
    s_nop 0
    s_cmp_ge_u32 s13, 8
    s_nop 1
    s_cbranch_scc1 Lwd_68
    s_sleep 1
    s_sub_u32 s15, s15, 1
    s_cmp_lg_u32 s15, 0
    s_cbranch_scc1 Lw_67
Lwd_68:
    ds_read_b128 v[160:163], v3
    ds_read_b128 v[164:167], v3 offset:16
    s_waitcnt lgkmcnt(0)
    v_max3_f32 v120, v160, v161, v162
    v_max3_f32 v120, v120, v163, v164
    v_max3_f32 v120, v120, v165, v166
    v_max_f32 v120, v120, v167
    v_sub_f32 v144, v144, v120
    v_sub_f32 v145, v145, v120
    v_sub_f32 v146, v146, v120
    v_sub_f32 v147, v147, v120
    v_sub_f32 v148, v148, v120
    v_sub_f32 v149, v149, v120
    v_sub_f32 v150, v150, v120
    v_sub_f32 v151, v151, v120
    v_sub_f32 v152, v152, v120
    v_sub_f32 v153, v153, v120
    v_sub_f32 v154, v154, v120
    v_sub_f32 v155, v155, v120
    v_sub_f32 v156, v156, v120
    v_sub_f32 v157, v157, v120
    v_sub_f32 v158, v158, v120
    v_sub_f32 v159, v159, v120
    v_mul_f32 v144, 0x3db8aa3b, v144
    v_mul_f32 v145, 0x3db8aa3b, v145
    v_mul_f32 v146, 0x3db8aa3b, v146
    v_mul_f32 v147, 0x3db8aa3b, v147
    v_mul_f32 v148, 0x3db8aa3b, v148
    v_mul_f32 v149, 0x3db8aa3b, v149
    v_mul_f32 v150, 0x3db8aa3b, v150
    v_mul_f32 v151, 0x3db8aa3b, v151
    v_mul_f32 v152, 0x3db8aa3b, v152
    v_mul_f32 v153, 0x3db8aa3b, v153
    v_mul_f32 v154, 0x3db8aa3b, v154
    v_mul_f32 v155, 0x3db8aa3b, v155
    v_mul_f32 v156, 0x3db8aa3b, v156
    v_mul_f32 v157, 0x3db8aa3b, v157
    v_mul_f32 v158, 0x3db8aa3b, v158
    v_mul_f32 v159, 0x3db8aa3b, v159
    v_exp_f32 v144, v144
    v_exp_f32 v145, v145
    v_exp_f32 v146, v146
    v_exp_f32 v147, v147
    v_exp_f32 v148, v148
    v_exp_f32 v149, v149
    v_exp_f32 v150, v150
    v_exp_f32 v151, v151
    v_exp_f32 v152, v152
    v_exp_f32 v153, v153
    v_exp_f32 v154, v154
    v_exp_f32 v155, v155
    v_exp_f32 v156, v156
    v_exp_f32 v157, v157
    v_exp_f32 v158, v158
    v_exp_f32 v159, v159
    v_cvt_pk_bf16_f32 v112, v144, v145
    v_cvt_pk_bf16_f32 v113, v146, v147
    v_cvt_pk_bf16_f32 v114, v148, v149
    v_cvt_pk_bf16_f32 v115, v150, v151
    v_cvt_pk_bf16_f32 v116, v152, v153
    v_cvt_pk_bf16_f32 v117, v154, v155
    v_cvt_pk_bf16_f32 v118, v156, v157
    v_cvt_pk_bf16_f32 v119, v158, v159
    v_add_f32 v121, v144, v145
    v_add_f32 v121, v121, v146
    v_add_f32 v121, v121, v147
    v_add_f32 v121, v121, v148
    v_add_f32 v121, v121, v149
    v_add_f32 v121, v121, v150
    v_add_f32 v121, v121, v151
    v_add_f32 v121, v121, v152
    v_add_f32 v121, v121, v153
    v_add_f32 v121, v121, v154
    v_add_f32 v121, v121, v155
    v_add_f32 v121, v121, v156
    v_add_f32 v121, v121, v157
    v_add_f32 v121, v121, v158
    v_add_f32 v121, v121, v159
    v_mov_b32 v6, v121
    s_nop 1
    v_permlane16_swap_b32 v121, v6
    v_add_f32 v121, v121, v6
    v_mov_b32 v6, v121
    s_nop 1
    v_permlane32_swap_b32 v121, v6
    v_add_f32 v121, v121, v6
    v_mov_b32 v6, 163508
    v_mov_b32 v7, 1
    s_mov_b64 exec, 3
    ds_write_b32 v4, v121 offset:64
    s_mov_b64 exec, 1
    ds_add_u32 v6, v7
    s_mov_b64 exec, -1
    v_and_b32 v2, 1, v1
    v_lshlrev_b32 v2, 10, v2
    v_and_b32 v7, 48, v1
    v_add_u32 v2, v2, v7
    v_bfe_u32 v7, v1, 1, 3
    v_lshl_add_u32 v2, v7, 6, v2
    v_add_u32 v2, s14, v2
    s_lshl_b32 s13, s3, 8
    v_and_b32 v3, 7, v1
    v_lshlrev_b32 v3, 4, v3
    v_and_b32 v7, 8, v1
    v_add_u32 v3, v3, v7
    v_and_b32 v7, 16, v1
    v_lshl_add_u32 v3, v7, 3, v3
    v_add_u32 v3, s13, v3
    v_add_u32 v4, 65536, v3
    s_lshr_b32 s13, s3, 2
    s_lshl_b32 s56, s13, 2
    s_add_u32 s56, s56, 163520
    v_mov_b32 v122, s56
    s_lshl_b32 s56, s6, 3
    s_add_u32 s56, s56, s4
    s_lshl_b32 s57, s56, 16
    s_lshl_b32 s58, s3, 13
    s_add_u32 s57, s57, s58
    s_lshl_b32 s58, s7, 8
    s_add_u32 s57, s57, s58
    s_add_u32 s57, s57, 1048576
    v_bfe_u32 v123, v1, 4, 1
    v_lshlrev_b32 v123, 12, v123
    v_and_b32 v7, 15, v1
    v_lshl_add_u32 v123, v7, 4, v123
    s_add_u32 s58, s57, 1048576
    s_mul_i32 s60, s3, 14
    s_add_u32 s60, s60, s5
    s_sub_u32 s60, s60, 18
    s_cmp_lt_u32 s60, 32
    s_cselect_b32 s59, 1, 0
    s_cmp_eq_u32 s10, 40
    s_cselect_b32 s59, s59, 0
    s_lshr_b32 s13, s60, 4
    s_lshl_b32 s13, s13, 7
    s_and_b32 s60, s60, 15
    s_add_u32 s60, s60, s13
    s_lshl_b32 s13, s4, 4
    s_add_u32 s60, s60, s13
    s_lshl_b32 s44, s60, 12
    s_add_u32 s44, s44, 1048576
    s_lshl_b32 s45, s60, 7
    s_add_u32 s45, s45, 65536
    v_mov_b32 v145, 163528
    v_lshlrev_b32 v144, 4, v1
    v_mov_b32 v149, s11
    v_mov_b32 v151, s11
    v_mov_b32 v125, s11
    v_mov_b32 v127, s11
    v_cndmask_b32 v128, 0, v112, s[18:19]
    v_cndmask_b32 v129, 0, v113, s[18:19]
    v_cndmask_b32 v130, 0, v112, s[20:21]
    v_cndmask_b32 v131, 0, v113, s[20:21]
    v_cndmask_b32 v132, 0, v112, s[22:23]
    v_cndmask_b32 v133, 0, v113, s[22:23]
    v_cndmask_b32 v134, 0, v112, s[24:25]
    v_cndmask_b32 v135, 0, v113, s[24:25]
    v_cndmask_b32 v136, 0, v112, s[26:27]
    v_cndmask_b32 v137, 0, v113, s[26:27]
    v_cndmask_b32 v138, 0, v112, s[28:29]
    v_cndmask_b32 v139, 0, v113, s[28:29]
    v_cndmask_b32 v140, 0, v112, s[30:31]
    v_cndmask_b32 v141, 0, v113, s[30:31]
    v_cndmask_b32 v142, 0, v112, s[32:33]
    v_cndmask_b32 v143, 0, v113, s[32:33]
    s_mov_b32 s15, 262136
    v_mov_b32 v6, 163464
Lw_69:
    ds_read_b32 v7, v6
    s_waitcnt lgkmcnt(0)
    v_readfirstlane_b32 s13, v7
    s_nop 0
    s_cmp_ge_u32 s13, s12
    s_nop 1
    s_cbranch_scc1 Lwd_70
    s_sleep 2
    s_sub_u32 s15, s15, 1
    s_cmp_lg_u32 s15, 0
    s_cbranch_scc1 Lw_69
Lwd_70:
    s_add_u32 s12, s12, 8
    ds_read_b64_tr_b16 v[80:81], v8 offset:0
    ds_read_b64_tr_b16 v[82:83], v8 offset:256
    ds_read_b64_tr_b16 v[84:85], v9 offset:0
    ds_read_b64_tr_b16 v[86:87], v9 offset:256
    ds_read_b64_tr_b16 v[88:89], v10 offset:0
    ds_read_b64_tr_b16 v[90:91], v10 offset:256
    ds_read_b64_tr_b16 v[92:93], v11 offset:0
    ds_read_b64_tr_b16 v[94:95], v11 offset:256
    ds_read_b64_tr_b16 v[96:97], v12 offset:0
    ds_read_b64_tr_b16 v[98:99], v12 offset:256
    ds_read_b64_tr_b16 v[100:101], v13 offset:0
    ds_read_b64_tr_b16 v[102:103], v13 offset:256
    ds_read_b64_tr_b16 v[104:105], v14 offset:0
    ds_read_b64_tr_b16 v[106:107], v14 offset:256
    ds_read_b64_tr_b16 v[108:109], v15 offset:0
    ds_read_b64_tr_b16 v[110:111], v15 offset:256
    s_waitcnt lgkmcnt(15)
    v_mfma_f32_16x16x16_bf16 v[16:19], v[80:81], v[128:129], 0
    s_waitcnt lgkmcnt(14)
    v_mfma_f32_16x16x16_bf16 v[20:23], v[82:83], v[128:129], 0
    s_waitcnt lgkmcnt(13)
    v_mfma_f32_16x16x16_bf16 v[16:19], v[84:85], v[130:131], v[16:19]
    s_waitcnt lgkmcnt(12)
    v_mfma_f32_16x16x16_bf16 v[20:23], v[86:87], v[130:131], v[20:23]
    s_waitcnt lgkmcnt(11)
    v_mfma_f32_16x16x16_bf16 v[16:19], v[88:89], v[132:133], v[16:19]
    s_waitcnt lgkmcnt(10)
    v_mfma_f32_16x16x16_bf16 v[20:23], v[90:91], v[132:133], v[20:23]
    s_waitcnt lgkmcnt(9)
    v_mfma_f32_16x16x16_bf16 v[16:19], v[92:93], v[134:135], v[16:19]
    s_waitcnt lgkmcnt(8)
    v_mfma_f32_16x16x16_bf16 v[20:23], v[94:95], v[134:135], v[20:23]
    s_waitcnt lgkmcnt(7)
    v_mfma_f32_16x16x16_bf16 v[16:19], v[96:97], v[136:137], v[16:19]
    s_waitcnt lgkmcnt(6)
    v_mfma_f32_16x16x16_bf16 v[20:23], v[98:99], v[136:137], v[20:23]
    s_waitcnt lgkmcnt(5)
    v_mfma_f32_16x16x16_bf16 v[16:19], v[100:101], v[138:139], v[16:19]
    s_waitcnt lgkmcnt(4)
    v_mfma_f32_16x16x16_bf16 v[20:23], v[102:103], v[138:139], v[20:23]
    s_waitcnt lgkmcnt(3)
    v_mfma_f32_16x16x16_bf16 v[16:19], v[104:105], v[140:141], v[16:19]
    s_waitcnt lgkmcnt(2)
    v_mfma_f32_16x16x16_bf16 v[20:23], v[106:107], v[140:141], v[20:23]
    s_waitcnt lgkmcnt(1)
    v_mfma_f32_16x16x16_bf16 v[16:19], v[108:109], v[142:143], v[16:19]
    s_waitcnt lgkmcnt(0)
    v_mfma_f32_16x16x16_bf16 v[20:23], v[110:111], v[142:143], v[20:23]
    v_mov_b32 v6, 5
    ds_write_b32 v5, v6
    v_cndmask_b32 v128, 0, v114, s[18:19]
    v_cndmask_b32 v129, 0, v115, s[18:19]
    v_cndmask_b32 v130, 0, v114, s[20:21]
    v_cndmask_b32 v131, 0, v115, s[20:21]
    v_cndmask_b32 v132, 0, v114, s[22:23]
    v_cndmask_b32 v133, 0, v115, s[22:23]
    v_cndmask_b32 v134, 0, v114, s[24:25]
    v_cndmask_b32 v135, 0, v115, s[24:25]
    v_cndmask_b32 v136, 0, v114, s[26:27]
    v_cndmask_b32 v137, 0, v115, s[26:27]
    v_cndmask_b32 v138, 0, v114, s[28:29]
    v_cndmask_b32 v139, 0, v115, s[28:29]
    v_cndmask_b32 v140, 0, v114, s[30:31]
    v_cndmask_b32 v141, 0, v115, s[30:31]
    v_cndmask_b32 v142, 0, v114, s[32:33]
    v_cndmask_b32 v143, 0, v115, s[32:33]
    s_mov_b32 s15, 262136
    v_mov_b32 v6, 163464
Lw_71:
    ds_read_b32 v7, v6
    s_waitcnt lgkmcnt(0)
    v_readfirstlane_b32 s13, v7
    s_nop 0
    s_cmp_ge_u32 s13, s12
    s_nop 1
    s_cbranch_scc1 Lwd_72
    s_sleep 2
    s_sub_u32 s15, s15, 1
    s_cmp_lg_u32 s15, 0
    s_cbranch_scc1 Lw_71
Lwd_72:
    s_add_u32 s12, s12, 8
    s_cmp_lg_u32 s3, 1
    s_cbranch_scc1 Lck_73
    s_memrealtime s[100:101]
    v_mov_b32 v6, 163516
    ds_read_b32 v7, v6
    s_waitcnt lgkmcnt(0)
    v_readfirstlane_b32 s60, v7
    s_nop 0
    s_cmp_eq_u32 s60, 0
    s_nop 1
    s_cbranch_scc1 Lck_73
    s_sub_u32 s60, s100, s60
    s_mov_b32 s61, 1
    s_cmp_ge_u32 s60, 1437
    s_addc_u32 s61, s61, 0
    s_cmp_ge_u32 s60, 1487
    s_addc_u32 s61, s61, 0
    s_cmp_ge_u32 s60, 1527
    s_addc_u32 s61, s61, 0
    s_cmp_ge_u32 s60, 1577
    s_addc_u32 s61, s61, 0
    v_mov_b32 v6, 163512
    v_mov_b32 v7, s61
    ds_write_b32 v6, v7
Lck_73:
    s_cmp_lg_u32 s3, 5
    s_cbranch_scc1 Lck_74
    s_memrealtime s[100:101]
    v_mov_b32 v6, 163516
    ds_read_b32 v7, v6
    s_waitcnt lgkmcnt(0)
    v_readfirstlane_b32 s60, v7
    s_nop 0
    s_cmp_eq_u32 s60, 0
    s_nop 1
    s_cbranch_scc1 Lck_74
    s_sub_u32 s60, s100, s60
    s_mov_b32 s61, 1
    s_cmp_ge_u32 s60, 1552
    s_addc_u32 s61, s61, 0
    s_cmp_ge_u32 s60, 1602
    s_addc_u32 s61, s61, 0
    s_cmp_ge_u32 s60, 1642
    s_addc_u32 s61, s61, 0
    s_cmp_ge_u32 s60, 1692
    s_addc_u32 s61, s61, 0
    v_mov_b32 v6, 163512
    v_mov_b32 v7, s61
    ds_write_b32 v6, v7
Lck_74:
    ds_read_b64_tr_b16 v[80:81], v8 offset:8192
    ds_read_b64_tr_b16 v[82:83], v8 offset:8448
    ds_read_b64_tr_b16 v[84:85], v9 offset:8192
    ds_read_b64_tr_b16 v[86:87], v9 offset:8448
    ds_read_b64_tr_b16 v[88:89], v10 offset:8192
    ds_read_b64_tr_b16 v[90:91], v10 offset:8448
    ds_read_b64_tr_b16 v[92:93], v11 offset:8192
    ds_read_b64_tr_b16 v[94:95], v11 offset:8448
    ds_read_b64_tr_b16 v[96:97], v12 offset:8192
    ds_read_b64_tr_b16 v[98:99], v12 offset:8448
    ds_read_b64_tr_b16 v[100:101], v13 offset:8192
    ds_read_b64_tr_b16 v[102:103], v13 offset:8448
    ds_read_b64_tr_b16 v[104:105], v14 offset:8192
    ds_read_b64_tr_b16 v[106:107], v14 offset:8448
    ds_read_b64_tr_b16 v[108:109], v15 offset:8192
    ds_read_b64_tr_b16 v[110:111], v15 offset:8448
    s_waitcnt lgkmcnt(15)
    v_mfma_f32_16x16x16_bf16 v[16:19], v[80:81], v[128:129], v[16:19]
    s_waitcnt lgkmcnt(14)
    v_mfma_f32_16x16x16_bf16 v[20:23], v[82:83], v[128:129], v[20:23]
    s_waitcnt lgkmcnt(13)
    v_mfma_f32_16x16x16_bf16 v[16:19], v[84:85], v[130:131], v[16:19]
    s_waitcnt lgkmcnt(12)
    v_mfma_f32_16x16x16_bf16 v[20:23], v[86:87], v[130:131], v[20:23]
    s_waitcnt lgkmcnt(11)
    v_mfma_f32_16x16x16_bf16 v[16:19], v[88:89], v[132:133], v[16:19]
    s_waitcnt lgkmcnt(10)
    v_mfma_f32_16x16x16_bf16 v[20:23], v[90:91], v[132:133], v[20:23]
    s_waitcnt lgkmcnt(9)
    v_mfma_f32_16x16x16_bf16 v[16:19], v[92:93], v[134:135], v[16:19]
    s_waitcnt lgkmcnt(8)
    v_mfma_f32_16x16x16_bf16 v[20:23], v[94:95], v[134:135], v[20:23]
    s_waitcnt lgkmcnt(7)
    v_mfma_f32_16x16x16_bf16 v[16:19], v[96:97], v[136:137], v[16:19]
    s_waitcnt lgkmcnt(6)
    v_mfma_f32_16x16x16_bf16 v[20:23], v[98:99], v[136:137], v[20:23]
    s_waitcnt lgkmcnt(5)
    v_mfma_f32_16x16x16_bf16 v[16:19], v[100:101], v[138:139], v[16:19]
    s_waitcnt lgkmcnt(4)
    v_mfma_f32_16x16x16_bf16 v[20:23], v[102:103], v[138:139], v[20:23]
    s_waitcnt lgkmcnt(3)
    v_mfma_f32_16x16x16_bf16 v[16:19], v[104:105], v[140:141], v[16:19]
    s_waitcnt lgkmcnt(2)
    v_mfma_f32_16x16x16_bf16 v[20:23], v[106:107], v[140:141], v[20:23]
    s_waitcnt lgkmcnt(1)
    v_mfma_f32_16x16x16_bf16 v[16:19], v[108:109], v[142:143], v[16:19]
    s_waitcnt lgkmcnt(0)
    v_mfma_f32_16x16x16_bf16 v[20:23], v[110:111], v[142:143], v[20:23]
    v_mov_b32 v6, 6
    ds_write_b32 v5, v6
    v_cndmask_b32 v128, 0, v116, s[18:19]
    v_cndmask_b32 v129, 0, v117, s[18:19]
    v_cndmask_b32 v130, 0, v116, s[20:21]
    v_cndmask_b32 v131, 0, v117, s[20:21]
    v_cndmask_b32 v132, 0, v116, s[22:23]
    v_cndmask_b32 v133, 0, v117, s[22:23]
    v_cndmask_b32 v134, 0, v116, s[24:25]
    v_cndmask_b32 v135, 0, v117, s[24:25]
    v_cndmask_b32 v136, 0, v116, s[26:27]
    v_cndmask_b32 v137, 0, v117, s[26:27]
    v_cndmask_b32 v138, 0, v116, s[28:29]
    v_cndmask_b32 v139, 0, v117, s[28:29]
    v_cndmask_b32 v140, 0, v116, s[30:31]
    v_cndmask_b32 v141, 0, v117, s[30:31]
    v_cndmask_b32 v142, 0, v116, s[32:33]
    v_cndmask_b32 v143, 0, v117, s[32:33]
    s_mov_b32 s15, 262136
    v_mov_b32 v6, 163464
Lw_75:
    ds_read_b32 v7, v6
    s_waitcnt lgkmcnt(0)
    v_readfirstlane_b32 s13, v7
    s_nop 0
    s_cmp_ge_u32 s13, s12
    s_nop 1
    s_cbranch_scc1 Lwd_76
    s_sleep 2
    s_sub_u32 s15, s15, 1
    s_cmp_lg_u32 s15, 0
    s_cbranch_scc1 Lw_75
Lwd_76:
    s_add_u32 s12, s12, 8
    s_cmp_lg_u32 s3, 1
    s_cbranch_scc1 Lck_77
    s_memrealtime s[100:101]
    v_mov_b32 v6, 163516
    ds_read_b32 v7, v6
    s_waitcnt lgkmcnt(0)
    v_readfirstlane_b32 s60, v7
    s_nop 0
    s_cmp_eq_u32 s60, 0
    s_nop 1
    s_cbranch_scc1 Lck_77
    s_sub_u32 s60, s100, s60
    s_mov_b32 s61, 1
    s_cmp_ge_u32 s60, 1654
    s_addc_u32 s61, s61, 0
    s_cmp_ge_u32 s60, 1704
    s_addc_u32 s61, s61, 0
    s_cmp_ge_u32 s60, 1744
    s_addc_u32 s61, s61, 0
    s_cmp_ge_u32 s60, 1794
    s_addc_u32 s61, s61, 0
    v_mov_b32 v6, 163512
    v_mov_b32 v7, s61
    ds_write_b32 v6, v7
Lck_77:
    s_cmp_lg_u32 s3, 5
    s_cbranch_scc1 Lck_78
    s_memrealtime s[100:101]
    v_mov_b32 v6, 163516
    ds_read_b32 v7, v6
    s_waitcnt lgkmcnt(0)
    v_readfirstlane_b32 s60, v7
    s_nop 0
    s_cmp_eq_u32 s60, 0
    s_nop 1
    s_cbranch_scc1 Lck_78
    s_sub_u32 s60, s100, s60
    s_mov_b32 s61, 1
    s_cmp_ge_u32 s60, 1755
    s_addc_u32 s61, s61, 0
    s_cmp_ge_u32 s60, 1805
    s_addc_u32 s61, s61, 0
    s_cmp_ge_u32 s60, 1845
    s_addc_u32 s61, s61, 0
    s_cmp_ge_u32 s60, 1895
    s_addc_u32 s61, s61, 0
    v_mov_b32 v6, 163512
    v_mov_b32 v7, s61
    ds_write_b32 v6, v7
Lck_78:
    ds_read_b64_tr_b16 v[80:81], v8 offset:0
    ds_read_b64_tr_b16 v[82:83], v8 offset:256
    ds_read_b64_tr_b16 v[84:85], v9 offset:0
    ds_read_b64_tr_b16 v[86:87], v9 offset:256
    ds_read_b64_tr_b16 v[88:89], v10 offset:0
    ds_read_b64_tr_b16 v[90:91], v10 offset:256
    ds_read_b64_tr_b16 v[92:93], v11 offset:0
    ds_read_b64_tr_b16 v[94:95], v11 offset:256
    ds_read_b64_tr_b16 v[96:97], v12 offset:0
    ds_read_b64_tr_b16 v[98:99], v12 offset:256
    ds_read_b64_tr_b16 v[100:101], v13 offset:0
    ds_read_b64_tr_b16 v[102:103], v13 offset:256
    ds_read_b64_tr_b16 v[104:105], v14 offset:0
    ds_read_b64_tr_b16 v[106:107], v14 offset:256
    ds_read_b64_tr_b16 v[108:109], v15 offset:0
    ds_read_b64_tr_b16 v[110:111], v15 offset:256
    s_waitcnt lgkmcnt(15)
    v_mfma_f32_16x16x16_bf16 v[16:19], v[80:81], v[128:129], v[16:19]
    s_waitcnt lgkmcnt(14)
    v_mfma_f32_16x16x16_bf16 v[20:23], v[82:83], v[128:129], v[20:23]
    s_waitcnt lgkmcnt(13)
    v_mfma_f32_16x16x16_bf16 v[16:19], v[84:85], v[130:131], v[16:19]
    s_waitcnt lgkmcnt(12)
    v_mfma_f32_16x16x16_bf16 v[20:23], v[86:87], v[130:131], v[20:23]
    s_waitcnt lgkmcnt(11)
    v_mfma_f32_16x16x16_bf16 v[16:19], v[88:89], v[132:133], v[16:19]
    s_waitcnt lgkmcnt(10)
    v_mfma_f32_16x16x16_bf16 v[20:23], v[90:91], v[132:133], v[20:23]
    s_waitcnt lgkmcnt(9)
    v_mfma_f32_16x16x16_bf16 v[16:19], v[92:93], v[134:135], v[16:19]
    s_waitcnt lgkmcnt(8)
    v_mfma_f32_16x16x16_bf16 v[20:23], v[94:95], v[134:135], v[20:23]
    s_waitcnt lgkmcnt(7)
    v_mfma_f32_16x16x16_bf16 v[16:19], v[96:97], v[136:137], v[16:19]
    s_waitcnt lgkmcnt(6)
    v_mfma_f32_16x16x16_bf16 v[20:23], v[98:99], v[136:137], v[20:23]
    s_waitcnt lgkmcnt(5)
    v_mfma_f32_16x16x16_bf16 v[16:19], v[100:101], v[138:139], v[16:19]
    s_waitcnt lgkmcnt(4)
    v_mfma_f32_16x16x16_bf16 v[20:23], v[102:103], v[138:139], v[20:23]
    s_waitcnt lgkmcnt(3)
    v_mfma_f32_16x16x16_bf16 v[16:19], v[104:105], v[140:141], v[16:19]
    s_waitcnt lgkmcnt(2)
    v_mfma_f32_16x16x16_bf16 v[20:23], v[106:107], v[140:141], v[20:23]
    s_waitcnt lgkmcnt(1)
    v_mfma_f32_16x16x16_bf16 v[16:19], v[108:109], v[142:143], v[16:19]
    s_waitcnt lgkmcnt(0)
    v_mfma_f32_16x16x16_bf16 v[20:23], v[110:111], v[142:143], v[20:23]
    v_cndmask_b32 v128, 0, v118, s[18:19]
    v_cndmask_b32 v129, 0, v119, s[18:19]
    v_cndmask_b32 v130, 0, v118, s[20:21]
    v_cndmask_b32 v131, 0, v119, s[20:21]
    v_cndmask_b32 v132, 0, v118, s[22:23]
    v_cndmask_b32 v133, 0, v119, s[22:23]
    v_cndmask_b32 v134, 0, v118, s[24:25]
    v_cndmask_b32 v135, 0, v119, s[24:25]
    v_cndmask_b32 v136, 0, v118, s[26:27]
    v_cndmask_b32 v137, 0, v119, s[26:27]
    v_cndmask_b32 v138, 0, v118, s[28:29]
    v_cndmask_b32 v139, 0, v119, s[28:29]
    v_cndmask_b32 v140, 0, v118, s[30:31]
    v_cndmask_b32 v141, 0, v119, s[30:31]
    v_cndmask_b32 v142, 0, v118, s[32:33]
    v_cndmask_b32 v143, 0, v119, s[32:33]
    s_mov_b32 s15, 262136
    v_mov_b32 v6, 163464
Lw_79:
    ds_read_b32 v7, v6
    s_waitcnt lgkmcnt(0)
    v_readfirstlane_b32 s13, v7
    s_nop 0
    s_cmp_ge_u32 s13, s12
    s_nop 1
    s_cbranch_scc1 Lwd_80
    s_sub_u32 s15, s15, 1
    s_cmp_lg_u32 s15, 0
    s_cbranch_scc1 Lw_79
Lwd_80:
    s_add_u32 s12, s12, 8
    ds_read_b64_tr_b16 v[80:81], v8 offset:8192
    ds_read_b64_tr_b16 v[82:83], v8 offset:8448
    ds_read_b64_tr_b16 v[84:85], v9 offset:8192
    ds_read_b64_tr_b16 v[86:87], v9 offset:8448
    ds_read_b64_tr_b16 v[88:89], v10 offset:8192
    ds_read_b64_tr_b16 v[90:91], v10 offset:8448
    ds_read_b64_tr_b16 v[92:93], v11 offset:8192
    ds_read_b64_tr_b16 v[94:95], v11 offset:8448
    ds_read_b64_tr_b16 v[96:97], v12 offset:8192
    ds_read_b64_tr_b16 v[98:99], v12 offset:8448
    ds_read_b64_tr_b16 v[100:101], v13 offset:8192
    ds_read_b64_tr_b16 v[102:103], v13 offset:8448
    ds_read_b64_tr_b16 v[104:105], v14 offset:8192
    ds_read_b64_tr_b16 v[106:107], v14 offset:8448
    ds_read_b64_tr_b16 v[108:109], v15 offset:8192
    ds_read_b64_tr_b16 v[110:111], v15 offset:8448
    s_waitcnt lgkmcnt(15)
    v_mfma_f32_16x16x16_bf16 v[16:19], v[80:81], v[128:129], v[16:19]
    s_waitcnt lgkmcnt(14)
    v_mfma_f32_16x16x16_bf16 v[20:23], v[82:83], v[128:129], v[20:23]
    s_waitcnt lgkmcnt(13)
    v_mfma_f32_16x16x16_bf16 v[16:19], v[84:85], v[130:131], v[16:19]
    s_waitcnt lgkmcnt(12)
    v_mfma_f32_16x16x16_bf16 v[20:23], v[86:87], v[130:131], v[20:23]
    s_waitcnt lgkmcnt(11)
    v_mfma_f32_16x16x16_bf16 v[16:19], v[88:89], v[132:133], v[16:19]
    s_waitcnt lgkmcnt(10)
    v_mfma_f32_16x16x16_bf16 v[20:23], v[90:91], v[132:133], v[20:23]
    s_waitcnt lgkmcnt(9)
    v_mfma_f32_16x16x16_bf16 v[16:19], v[92:93], v[134:135], v[16:19]
    s_waitcnt lgkmcnt(8)
    v_mfma_f32_16x16x16_bf16 v[20:23], v[94:95], v[134:135], v[20:23]
    s_waitcnt lgkmcnt(7)
    v_mfma_f32_16x16x16_bf16 v[16:19], v[96:97], v[136:137], v[16:19]
    s_waitcnt lgkmcnt(6)
    v_mfma_f32_16x16x16_bf16 v[20:23], v[98:99], v[136:137], v[20:23]
    s_waitcnt lgkmcnt(5)
    v_mfma_f32_16x16x16_bf16 v[16:19], v[100:101], v[138:139], v[16:19]
    s_waitcnt lgkmcnt(4)
    v_mfma_f32_16x16x16_bf16 v[20:23], v[102:103], v[138:139], v[20:23]
    s_waitcnt lgkmcnt(3)
    v_mfma_f32_16x16x16_bf16 v[16:19], v[104:105], v[140:141], v[16:19]
    s_waitcnt lgkmcnt(2)
    v_mfma_f32_16x16x16_bf16 v[20:23], v[106:107], v[140:141], v[20:23]
    s_waitcnt lgkmcnt(1)
    v_mfma_f32_16x16x16_bf16 v[16:19], v[108:109], v[142:143], v[16:19]
    s_waitcnt lgkmcnt(0)
    v_mfma_f32_16x16x16_bf16 v[20:23], v[110:111], v[142:143], v[20:23]
    s_nop 5
    ds_write_b128 v2, v[16:19]
    s_nop 0
    ds_write_b128 v2, v[20:23] offset:512
    s_waitcnt lgkmcnt(0)
    s_barrier
    ds_read_b64 v[96:97], v3 offset:0
    ds_read_b64 v[98:99], v3 offset:16384
    ds_read_b64 v[100:101], v3 offset:32768
    ds_read_b64 v[102:103], v3 offset:49152
    ds_read_b64 v[104:105], v4 offset:0
    ds_read_b64 v[106:107], v4 offset:16384
    ds_read_b64 v[108:109], v4 offset:32768
    ds_read_b64 v[110:111], v4 offset:49152
    ds_read_b32 v6, v122
    ds_read_b32 v7, v145
    s_waitcnt lgkmcnt(6)
    v_add_f32 v96, v96, v98
    v_add_f32 v100, v100, v102
    v_add_f32 v97, v97, v99
    v_add_f32 v101, v101, v103
    s_waitcnt lgkmcnt(0)
    v_readfirstlane_b32 s42, v7
    v_add_f32 v104, v104, v106
    v_add_f32 v108, v108, v110
    v_add_f32 v105, v105, v107
    v_add_f32 v109, v109, v111
    v_add_f32 v96, v96, v100
    v_add_f32 v104, v104, v108
    v_add_f32 v97, v97, v101
    v_add_f32 v105, v105, v109
    v_add_f32 v96, v96, v104
    v_add_f32 v97, v97, v105
    s_waitcnt lgkmcnt(0)
    v_mul_f32 v124, v96, v6
    v_mul_f32 v126, v97, v6
    s_mov_b32 exec_hi, 0
    s_cmp_lg_u32 s42, 1
    s_cbranch_scc1 Lsg_81
    buffer_store_dwordx4 v[124:127], v123, s[52:55], s57 offen
Lsd_82:
L_a2:
    s_barrier
    s_cmp_eq_u32 s59, 1
    s_cbranch_scc1 L_hop1
    s_mov_b64 exec, -1
    s_cmp_lt_u32 s10, 28
    s_cbranch_scc1 L_a_gu
    s_cmp_lt_u32 s10, 56
    s_cbranch_scc1 L_a_wo
    s_cmp_ge_u32 s10, 63
    s_cbranch_scc1 L_aend
    s_cmp_ge_u32 s3, 5
    s_cbranch_scc1 L_aend
    s_barrier
    s_cmp_lg_u32 s3, 0
    s_cbranch_scc1 L_a_dn2
    s_sub_u32 s62, s10, 56
    s_lshl_b32 s62, s62, 2
    s_add_u32 s62, s62, s9
    v_bfe_u32 v4, v1, 4, 1
    v_and_b32 v5, 15, v1
    v_mul_u32_u24 v6, 896, v4
    v_lshl_add_u32 v6, v5, 1, v6
    s_lshl_b32 s14, s62, 5
    v_add_u32 v52, s14, v6
    v_lshrrev_b32 v8, 1, v5
    v_lshlrev_b32 v8, 3, v8
    v_lshl_add_u32 v7, v4, 6, v8
    v_lshl_add_u32 v6, v4, 7, v8
    s_mul_i32 s14, s4, 14
    s_lshr_b32 s13, s62, 1
    s_add_u32 s14, s14, s13
    s_lshl_b32 s14, s14, 10
    s_and_b32 s13, s62, 1
    s_lshl_b32 s13, s13, 6
    s_add_u32 s14, s14, s13
    s_add_u32 s14, s14, 557568
    s_lshl_b32 s12, s62, 7
    s_add_u32 s12, s12, 22016
    v_min_u32 v10, 13, v5
    v_lshlrev_b32 v10, 10, v10
    s_mul_i32 s44, s4, 14336
    s_add_u32 s44, s44, 557824
    s_mov_b32 s15, 32767
Lpoll_83:
    buffer_load_dwordx2 v[32:33], v6, s[52:55], s14 offen sc1
    buffer_load_dwordx2 v[34:35], v7, s[52:55], s12 offen sc1
    buffer_load_dwordx2 v[36:37], v10, s[52:55], s44 offen sc1
    s_waitcnt vmcnt(0)
    v_xor_b32 v8, s11, v33
    v_bitop3_b32 v8, v8, v35, s11 bitop3:0xf6
    v_bitop3_b32 v8, v8, v37, s11 bitop3:0xf6
    v_cmp_ne_u32 vcc, 0, v8
    s_nop 0
    s_cbranch_vccz Lpolld_84
    s_sleep 1
    s_sub_u32 s15, s15, 1
    s_cmp_lg_u32 s15, 0
    s_cbranch_scc1 Lpoll_83
Lpolld_84:
    s_cmp_eq_u32 s15, 32767
    s_cselect_b32 s13, 2, 1
    v_mov_b32 v8, 163468
    v_mov_b32 v9, s13
    ds_write_b32 v8, v9
    v_and_b32 v8, 1, v1
    v_cmp_ne_u32 vcc, 0, v8
    v_lshlrev_b32 v53, 16, v32
    v_and_b32 v9, 0xffff0000, v32
    v_cndmask_b32 v53, v53, v9, vcc
    v_lshlrev_b32 v54, 16, v34
    v_and_b32 v9, 0xffff0000, v34
    v_cndmask_b32 v54, v54, v9, vcc
    v_lshlrev_b32 v4, 4, v1
    s_lshl_b32 s14, s62, 10
    s_add_u32 s14, s14, 786432
    s_mov_b32 s64, s38
    s_mov_b32 s65, s39
    s_mov_b32 s66, 1792
    s_mov_b32 s67, 0x20000
    v_and_b32 v8, 16, v1
    v_cmp_ne_u32 s[44:45], 0, v8
    buffer_load_dwordx4 v[16:19], v4, s[52:55], s14 offen sc1
    s_barrier
    s_mov_b32 s15, 32767
Lpoll_85:
    buffer_load_dwordx4 v[16:19], v4, s[52:55], s14 offen sc1
    s_waitcnt vmcnt(0)
    v_xor_b32 v8, s11, v17
    v_bitop3_b32 v8, v8, v19, s11 bitop3:0xf6
    v_cmp_ne_u32 vcc, 0, v8
    s_nop 0
    s_cbranch_vccz Lpolld_86
    s_sub_u32 s15, s15, 1
    s_cmp_lg_u32 s15, 0
    s_cbranch_scc1 Lpoll_85
Lpolld_86:
    v_mov_b32 v10, v16
    v_mov_b32 v11, v18
    s_nop 0
    v_permlane16_swap_b32 v16, v10
    v_permlane16_swap_b32 v18, v11
    v_add_f32 v16, v16, v10
    v_add_f32 v18, v18, v11
    v_mov_b32 v10, v16
    v_mov_b32 v11, v18
    s_nop 0
    v_permlane32_swap_b32 v16, v10
    v_permlane32_swap_b32 v18, v11
    v_add_f32 v16, v16, v10
    v_add_f32 v18, v18, v11
    v_cndmask_b32 v8, v16, v18, s[44:45]
    v_cvt_pk_bf16_f32 v8, v8, v8
    v_lshlrev_b32 v8, 16, v8
    v_mul_f32 v8, v8, v54
    v_cvt_pk_bf16_f32 v8, v8, v8
    v_lshlrev_b32 v8, 16, v8
    v_add_f32 v8, v8, v53
    v_cvt_pk_bf16_f32 v8, v8, v8
    s_mov_b32 exec_hi, 0
    buffer_store_short v8, v52, s[64:67], 0 offen
    s_mov_b64 exec, -1
    s_cmp_lg_u32 s62, 0
    s_cbranch_scc1 L_aend
    v_mov_b32 v8, s11
    v_mov_b32 v9, 0
    s_mov_b64 exec, 1
    buffer_store_dword v8, v9, s[52:55], 0 offen sc1
    s_mov_b64 exec, -1
    s_branch L_aend
L_a_dn2:
    v_min_u32 v9, 55, v1
    v_lshlrev_b32 v4, 4, v9
    v_bfe_u32 v10, v9, 2, 1
    v_mul_u32_u24 v10, 928, v10
    v_and_b32 v8, 3, v9
    v_lshl_add_u32 v10, v8, 3, v10
    v_lshrrev_b32 v8, 3, v9
    v_lshl_add_u32 v10, v8, 5, v10
    s_sub_u32 s12, s3, 1
    s_mul_i32 s13, s12, 224
    s_add_u32 s13, s13, 0
    v_add_u32 v10, s13, v10
    s_lshl_b32 s14, s9, 2
    s_add_u32 s14, s14, s12
    s_mul_i32 s14, s14, 896
    s_add_u32 s14, s14, 98304
    s_add_u32 s12, s14, 14336
    s_mov_b32 s15, 262136
    v_mov_b32 v8, 163468
Lw_87:
    ds_read_b32 v9, v8
    s_waitcnt lgkmcnt(0)
    v_readfirstlane_b32 s13, v9
    s_nop 0
    s_cmp_ge_u32 s13, 1
    s_nop 1
    s_cbranch_scc1 Lwd_88
    s_sleep 1
    s_sub_u32 s15, s15, 1
    s_cmp_lg_u32 s15, 0
    s_cbranch_scc1 Lw_87
Lwd_88:
    s_cmp_eq_u32 s13, 2
    s_cbranch_scc1 L_nodd
    s_sleep 18
L_nodd:
    s_mov_b32 s15, 32767
Lpoll_89:
    buffer_load_dwordx4 v[16:19], v4, s[52:55], s14 offen sc1
    buffer_load_dwordx4 v[20:23], v4, s[52:55], s12 offen sc1
    s_waitcnt vmcnt(0)
    v_xor_b32 v8, s11, v17
    v_bitop3_b32 v8, v8, v19, s11 bitop3:0xf6
    v_bitop3_b32 v8, v8, v21, s11 bitop3:0xf6
    v_bitop3_b32 v8, v8, v23, s11 bitop3:0xf6
    v_cmp_ne_u32 vcc, 0, v8
    s_nop 0
    s_cbranch_vccz Lpolld_90
    s_sub_u32 s15, s15, 1
    s_cmp_lg_u32 s15, 0
    s_cbranch_scc1 Lpoll_89
Lpolld_90:
    v_lshlrev_b32 v32, 16, v16
    v_and_b32 v33, 0xffff0000, v16
    v_lshlrev_b32 v34, 16, v20
    v_and_b32 v35, 0xffff0000, v20
    v_lshlrev_b32 v36, 16, v18
    v_and_b32 v37, 0xffff0000, v18
    v_lshlrev_b32 v38, 16, v22
    v_and_b32 v39, 0xffff0000, v22
    v_mul_f32 v32, v32, v34
    v_mul_f32 v33, v33, v35
    v_mul_f32 v36, v36, v38
    v_mul_f32 v37, v37, v39
    v_cvt_pk_bf16_f32 v16, v32, v33
    v_cvt_pk_bf16_f32 v17, v36, v37
    ds_write_b64 v10, v[16:17]
    s_waitcnt lgkmcnt(0)
    s_barrier
    s_branch L_aend
L_hop1:
    s_mov_b64 exec, -1
    s_mov_b32 s15, 32767
    s_mov_b32 s13, s44
L_h1p:
    buffer_load_dwordx4 v[16:19], v144, s[52:55], s13 offen offset:0 sc1
    buffer_load_dwordx4 v[20:23], v144, s[52:55], s13 offen offset:1024 sc1
    buffer_load_dwordx4 v[24:27], v144, s[52:55], s13 offen offset:2048 sc1
    buffer_load_dwordx4 v[28:31], v144, s[52:55], s13 offen offset:3072 sc1
    s_sub_u32 s15, s15, 1
    s_waitcnt vmcnt(0)
    v_xor_b32 v7, s11, v17
    v_bitop3_b32 v7, v7, v19, s11 bitop3:0xf6
    v_bitop3_b32 v7, v7, v21, s11 bitop3:0xf6
    v_bitop3_b32 v7, v7, v23, s11 bitop3:0xf6
    v_bitop3_b32 v7, v7, v25, s11 bitop3:0xf6
    v_bitop3_b32 v7, v7, v27, s11 bitop3:0xf6
    v_bitop3_b32 v7, v7, v29, s11 bitop3:0xf6
    v_bitop3_b32 v7, v7, v31, s11 bitop3:0xf6
    v_cmp_ne_u32 vcc, 0, v7
    s_nop 0
    s_cbranch_vccz L_h1d
    s_cmp_lg_u32 s15, 0
    s_cbranch_scc1 L_h1p
L_h1d:
    v_add_f32 v8, v16, v20
    v_add_f32 v9, v18, v22
    v_add_f32 v10, v24, v28
    v_add_f32 v11, v26, v30
    v_add_f32 v8, v8, v10
    v_add_f32 v9, v9, v11
    v_mov_b32 v10, v8
    v_mov_b32 v11, v9
    s_nop 0
    v_permlane16_swap_b32 v8, v10
    v_permlane16_swap_b32 v9, v11
    v_add_f32 v8, v8, v10
    v_add_f32 v9, v9, v11
    v_mov_b32 v10, v8
    v_mov_b32 v11, v9
    s_nop 0
    v_permlane32_swap_b32 v8, v10
    v_permlane32_swap_b32 v9, v11
    v_add_f32 v8, v8, v10
    v_add_f32 v9, v9, v11
    v_cvt_pk_bf16_f32 v148, v8, v9
    s_mov_b32 exec_hi, 0
    s_nop 0
    v_mov_b32_dpp v150, v148 row_ror:8 row_mask:0xf bank_mask:0xf
    s_mov_b32 exec_lo, 0xff
    s_cmp_lg_u32 s42, 1
    s_cbranch_scc1 Lsg_91
    buffer_store_dwordx4 v[148:151], v144, s[52:55], s45 offen
Lsd_92:
    s_mov_b32 exec_lo, -1
    s_mov_b64 exec, -1
L_a_wo:
    s_branch L_aend
L_a_gu1:
    s_branch L_aend
L_a_gu:
    s_cmp_lg_u32 s3, 0
    s_cbranch_scc1 L_a_gu1
    v_and_b32 v5, 15, v1
    v_min_u32 v4, 13, v5
    v_lshlrev_b32 v4, 10, v4
    v_and_b32 v6, 16, v1
    v_add_u32 v4, v4, v6
    v_lshrrev_b32 v3, 1, v6
    v_add_u32 v3, 163536, v3
    s_mul_i32 s14, s4, 14336
    s_add_u32 s14, s14, 557824
    v_cmp_gt_u32 s[44:45], 14, v5
    s_barrier
    s_mov_b32 s15, 32767
Lpoll_93:
    buffer_load_dwordx4 v[16:19], v4, s[52:55], s14 offen sc1
    s_waitcnt vmcnt(0)
    v_xor_b32 v8, s11, v17
    v_bitop3_b32 v8, v8, v19, s11 bitop3:0xf6
    v_cmp_ne_u32 vcc, 0, v8
    s_nop 0
    s_cbranch_vccz Lpolld_94
    s_sub_u32 s15, s15, 1
    s_cmp_lg_u32 s15, 0
    s_cbranch_scc1 Lpoll_93
Lpolld_94:
    v_mov_b32_dpp v10, v16 row_newbcast:0 row_mask:0xf bank_mask:0xf
    v_sub_f32 v8, v16, v10
    v_mul_f32 v9, v8, v8
    v_fmac_f32 v18, 0x42000000, v9
    v_cndmask_b32 v8, 0, v8, s[44:45]
    v_cndmask_b32 v9, 0, v18, s[44:45]
    s_nop 0
    v_add_f32_dpp v8, v8, v8 quad_perm:[1,0,3,2] row_mask:0xf bank_mask:0xf
    v_add_f32_dpp v9, v9, v9 quad_perm:[1,0,3,2] row_mask:0xf bank_mask:0xf
    s_nop 0
    v_add_f32_dpp v8, v8, v8 quad_perm:[2,3,0,1] row_mask:0xf bank_mask:0xf
    v_add_f32_dpp v9, v9, v9 quad_perm:[2,3,0,1] row_mask:0xf bank_mask:0xf
    s_nop 0
    v_add_f32_dpp v8, v8, v8 row_half_mirror row_mask:0xf bank_mask:0xf
    v_add_f32_dpp v9, v9, v9 row_half_mirror row_mask:0xf bank_mask:0xf
    s_nop 0
    v_add_f32_dpp v8, v8, v8 row_mirror row_mask:0xf bank_mask:0xf
    v_add_f32_dpp v9, v9, v9 row_mirror row_mask:0xf bank_mask:0xf
    v_mul_f32 v8, 0x3d924925, v8
    v_mul_f32 v9, 0x3b124925, v9
    v_fma_f32 v9, -v8, v8, v9
    v_add_f32 v8, v8, v10
    v_max_f32 v9, 0, v9
    v_cvt_pk_bf16_f32 v8, v8, v8
    v_lshlrev_b32 v8, 16, v8
    v_cvt_pk_bf16_f32 v9, v9, v9
    v_lshlrev_b32 v9, 16, v9
    v_add_f32 v9, 0x3727c5ac, v9
    v_cvt_pk_bf16_f32 v9, v9, v9
    v_lshlrev_b32 v9, 16, v9
    v_sqrt_f32 v9, v9
    s_nop 0
    v_cvt_pk_bf16_f32 v9, v9, v9
    v_lshlrev_b32 v9, 16, v9
    v_rcp_f32 v9, v9
    s_nop 0
    ds_write_b64 v3, v[8:9]
    s_waitcnt lgkmcnt(0)
    s_barrier
L_aend:
L_end:
    s_endpgm
Lsg_41:
    buffer_store_dwordx4 v[12:15], v3, s[52:55], s12 offen sc1
    s_nop 0
    s_branch Lsd_42
Lsg_43:
    buffer_store_dwordx4 v[64:67], v5, s[52:55], s12 offen sc1
    s_nop 0
    s_branch Lsd_44
Lsg_45:
    buffer_store_dwordx4 v[64:67], v5, s[52:55], s12 offen sc1
    s_nop 0
    s_branch Lsd_46
Lsg_49:
    buffer_store_dwordx4 v[128:131], v9, s[52:55], s12 offen sc1
    s_nop 0
    s_branch Lsd_50
Lsg_81:
    buffer_store_dwordx4 v[124:127], v123, s[52:55], s57 offen sc1
    s_nop 0
    s_branch Lsd_82
Lsg_91:
    buffer_store_dwordx4 v[148:151], v144, s[52:55], s45 offen sc1
    s_nop 0
    s_branch Lsd_92
L_codeend:
.section .rodata,"a"
.p2align 6
.amdhsa_kernel adaLN_cond__gqa_block_cached__swiglu_ffn__decode_kernel
  .amdhsa_next_free_vgpr 168
  .amdhsa_next_free_sgpr 102
  .amdhsa_accum_offset 168
  .amdhsa_group_segment_fixed_size 0
  .amdhsa_kernarg_size 112
  .amdhsa_user_sgpr_count 2
  .amdhsa_user_sgpr_kernarg_segment_ptr 1
  .amdhsa_system_sgpr_workgroup_id_x 1
.end_amdhsa_kernel
```
